```python
import torch

def _softmax(x, axis=-1):
    return torch.softmax(x, dim=axis)
def _gelu(x):
    return torch.nn.functional.gelu(x, approximate="tanh")
def _silu(x):
    return torch.nn.functional.silu(x)
def _sigmoid(x):
    return torch.sigmoid(x)
def _layernorm(x, axis=-1, eps=1e-5):
    m = x.mean(dim=axis, keepdim=True)
    v = x.var(dim=axis, keepdim=True, unbiased=False)
    return (x - m) / torch.sqrt(v + eps)
def _scatter_add(tgt, idx, src, axis=0):
    return tgt.clone().index_add_(axis, idx, src)
def _segment_sum(src, seg, n):
    out = torch.zeros((n,) + src.shape[1:], dtype=src.dtype)
    return out.index_add_(0, seg, src)
def _pad(x, pw):
    flat = tuple(v for pair in reversed(pw) for v in pair)
    return torch.nn.functional.pad(x, flat)

kernel_name = 'parallel_sum__mha_block_cached__geglu_ffn__decode'

def setup_inputs():

    _w = (lambda a: (lambda t: t.to(torch.bfloat16) if t.is_floating_point() else t)(torch.as_tensor(a)))
    def _A_setup():
        B, Sq, D = 2, 1, 512
        H, Sk, Dh = 32, 4096, 128
        return {
            "x": _w((lambda *s: torch.randn(*s, dtype=torch.bfloat16) * 0.05)(B, Sq, D)),
            "k_cache": _w((lambda *s: torch.randn(*s, dtype=torch.bfloat16) * 3.2)(B, H, Sk, Dh)),
            "v_cache": _w((lambda *s: torch.randn(*s, dtype=torch.bfloat16) * 1.6)(B, H, Sk, Dh)),
            "wq": _w((lambda *s: torch.randn(*s, dtype=torch.bfloat16) * 3.2)(D, H * Dh) * (D ** -0.5)),
            "wo": _w((lambda *s: torch.randn(*s, dtype=torch.bfloat16) * 1.6)(H * Dh, D) * ((H * Dh) ** -0.5)),
        }
    _A_in = _A_setup()

    def _B_setup():
        B, S, D, F = 2, 1, 512, 1376
        return {
            "x": _w((lambda *s: torch.randn(*s, dtype=torch.bfloat16) * 0.05)(B, S, D)),
            "w_gate": _w((lambda *s: torch.randn(*s, dtype=torch.bfloat16) * 0.05)(D, F)),
            "w_up": _w((lambda *s: torch.randn(*s, dtype=torch.bfloat16) * 0.05)(D, F)),
            "w_down": _w((lambda *s: torch.randn(*s, dtype=torch.bfloat16) * 0.05)(F, D)),
        }
    _B_in = _B_setup()

    return {
        "A_x": _A_in["x"],
        "A_k_cache": _A_in["k_cache"],
        "A_v_cache": _A_in["v_cache"],
        "A_wq": _A_in["wq"],
        "A_wo": _A_in["wo"],
        "B_x": _B_in["x"],
        "B_w_gate": _B_in["w_gate"],
        "B_w_up": _B_in["w_up"],
        "B_w_down": _B_in["w_down"],
    }

def reference(A_x, A_k_cache, A_v_cache, A_wq, A_wo, B_x, B_w_gate, B_w_up, B_w_down):
    def _A_ref(x, k_cache, v_cache, wq, wo):
        B, Sq, D = x.shape
        H, Dh = 32, 128
        q = (lambda x, *d: x.permute(*d))((x @ wq).reshape(B, Sq, H, Dh), 0, 2, 1, 3)
        scores = torch.einsum("bhqd,bhkd->bhqk", q, k_cache) * (Dh ** -0.5)
        p = _softmax(scores, axis=-1)
        o = torch.einsum("bhqk,bhkd->bhqd", p, v_cache)
        return (lambda x, *d: x.permute(*d))(o, 0, 2, 1, 3).reshape(B, Sq, H * Dh) @ wo

    def _B_ref(x, w_gate, w_up, w_down):
        return (_gelu(x @ w_gate) * (x @ w_up)) @ w_down

    x = A_x
    xn = _layernorm(x, axis=-1)
    return x + _A_ref(xn, A_k_cache, A_v_cache, A_wq, A_wo) + _B_ref(xn, B_w_gate, B_w_up, B_w_down)
```

```asm
; @launch grid=(256,1,1) block=(640,1,1) lds=8192
.amdgcn_target "amdgcn-amd-amdhsa--gfx950"
.text
.globl parallel_sum__mha_block_cached__geglu_ffn__decode_kernel
.p2align 8
.type parallel_sum__mha_block_cached__geglu_ffn__decode_kernel,@function
parallel_sum__mha_block_cached__geglu_ffn__decode_kernel:
  s_cmp_ge_u32 s2, 256
  s_cbranch_scc1 L_end
  v_lshrrev_b32 v1, 6, v0
  v_and_b32 v0, 63, v0
  v_readfirstlane_b32 s3, v1
  s_cmp_lg_u32 s3, 9
  s_cbranch_scc1 L_noinit
  v_mov_b32 v20, -1
  v_mov_b32 v21, -1
  v_lshlrev_b32 v16, 3, v0
  ds_write_b64 v16, v[20:21] offset:0
  s_waitcnt lgkmcnt(0)
L_noinit:
  s_load_dwordx16 s[16:31], s[0:1], 0
  s_load_dwordx8 s[32:39], s[0:1], 64
  s_barrier
  s_and_b32 s4, s2, 7
  s_lshr_b32 s5, s2, 6
  s_lshl_b32 s4, s4, 2
  s_add_u32 s4, s4, s5
  s_bfe_u32 s5, s2, 0x30003
  s_lshr_b32 s6, s5, 2
  s_and_b32 s7, s5, 3
  v_lshlrev_b32 v3, 4, v0
  s_cmp_ge_u32 s3, 8
  s_cbranch_scc1 L_helper
  s_setprio 2
  s_lshl_b32 s8, s6, 5
  s_add_u32 s8, s8, s4
  s_lshl_b32 s8, s8, 20
  s_mov_b32 s42, 0x100000
  s_mov_b32 s43, 0x20000
  s_mov_b32 s9, 0
  s_bitcmp1_b32 s3, 0
  s_cselect_b32 s10, 0x100, 0
  s_xor_b32 s9, s9, s10
  s_bitcmp1_b32 s3, 1
  s_cselect_b32 s10, 0x1000, 0
  s_xor_b32 s9, s9, s10
  s_bitcmp1_b32 s3, 2
  s_cselect_b32 s10, 0x10000, 0
  s_xor_b32 s9, s9, s10
  s_bitcmp1_b32 s2, 3
  s_cselect_b32 s10, 0x4000, 0
  s_xor_b32 s9, s9, s10
  s_bitcmp1_b32 s2, 4
  s_cselect_b32 s10, 0x8000, 0
  s_xor_b32 s9, s9, s10
  v_and_b32 v3, 15, v0
  v_lshlrev_b32 v3, 4, v3
  v_bfe_i32 v1, v0, 4, 1
  v_and_b32 v1, 0x400, v1
  v_xor_b32 v3, v3, v1
  v_bfe_i32 v1, v0, 5, 1
  v_and_b32 v1, 0x2000, v1
  v_xor_b32 v3, v3, v1
  v_xor_b32 v3, s9, v3
  s_mov_b32 s9, 0
  v_add_u32 v1, s9, v3
  s_waitcnt lgkmcnt(0)
  s_add_u32 s40, s18, s8
  s_addc_u32 s41, s19, 0
  s_memrealtime s[24:25]
  buffer_load_dwordx4 v[28:31], v1, s[40:43], 0 offen nt
  s_mov_b32 s64, 2048
  buffer_load_dwordx4 v[32:35], v1, s[40:43], s64 offen nt
  s_mov_b32 s64, 512
  buffer_load_dwordx4 v[36:39], v1, s[40:43], s64 offen nt
  s_branch L_smain_e
L_helper:
  v_and_b32 v1, 15, v0
  v_lshrrev_b32 v2, 4, v0
  s_lshl_b32 s13, s5, 7
  s_mov_b32 s12, 0xffff0000
  s_cmp_eq_u32 s3, 9
  s_cbranch_scc0 L_hq
  s_getpc_b64 s[44:45]
L_pc:
  s_sub_u32 s44, s44, L_pc-parallel_sum__mha_block_cached__geglu_ffn__decode_kernel
  s_subb_u32 s45, s45, 0
  s_mov_b32 s46, L_code_end-parallel_sum__mha_block_cached__geglu_ffn__decode_kernel
  s_mov_b32 s47, 0x20000
  s_lshr_b32 s8, s2, 3
  s_lshl_b32 s8, s8, 10
  v_lshlrev_b32 v16, 7, v0
  v_add_u32 v16, s8, v16
  s_mov_b64 exec, 0xff
  buffer_load_dword v26, v16, s[44:47], 0 offen
  s_mov_b64 exec, -1
  s_waitcnt lgkmcnt(0)
  s_branch L_hf
L_hq:
  s_setprio 1
  v_lshlrev_b32 v14, 1, v0
  v_lshlrev_b32 v18, 17, v2
  v_lshl_add_u32 v18, v1, 4, v18
  s_lshl_b32 s8, s5, 19
  s_lshl_b32 s9, s4, 8
  s_add_u32 s8, s8, s9
  s_mov_b32 s58, 2048
  s_mov_b32 s59, 0x20000
  s_mov_b32 s42, 0x400000
  s_mov_b32 s43, 0x20000
  s_waitcnt lgkmcnt(0)
  s_memrealtime s[46:47]
  s_mov_b64 s[56:57], s[16:17]
  s_mov_b64 s[40:41], s[22:23]
  buffer_load_dwordx4 v[4:7], v3, s[56:59], 0 offen
  buffer_load_dwordx4 v[8:11], v3, s[56:59], 0 offen offset:1024
  buffer_load_ushort v12, v14, s[56:59], s13 offen
  buffer_load_ushort v13, v14, s[56:59], s13 offen offset:1024
  s_load_dword s63, s[38:39], 1015808
  s_getreg_b32 s55, hwreg(HW_REG_XCC_ID, 0, 3)
  s_cmp_lt_u32 s2, 8
  s_cbranch_scc1 L_acini
L_acind:
  buffer_load_dwordx4 v[32:35], v18, s[40:43], s8 offen nt
  s_add_u32 s8, s8, 0x2000
  buffer_load_dwordx4 v[36:39], v18, s[40:43], s8 offen nt
  s_add_u32 s8, s8, 0x2000
  buffer_load_dwordx4 v[40:43], v18, s[40:43], s8 offen nt
  s_add_u32 s8, s8, 0x2000
  buffer_load_dwordx4 v[44:47], v18, s[40:43], s8 offen nt
  s_add_u32 s8, s8, 0x2000
  buffer_load_dwordx4 v[48:51], v18, s[40:43], s8 offen nt
  s_add_u32 s8, s8, 0x2000
  buffer_load_dwordx4 v[52:55], v18, s[40:43], s8 offen nt
  s_add_u32 s8, s8, 0x2000
  buffer_load_dwordx4 v[56:59], v18, s[40:43], s8 offen nt
  s_add_u32 s8, s8, 0x2000
  buffer_load_dwordx4 v[60:63], v18, s[40:43], s8 offen nt
  s_add_u32 s8, s8, 0x2000
  buffer_load_dwordx4 v[64:67], v18, s[40:43], s8 offen nt
  s_add_u32 s8, s8, 0x2000
  buffer_load_dwordx4 v[68:71], v18, s[40:43], s8 offen nt
  s_add_u32 s8, s8, 0x2000
  buffer_load_dwordx4 v[72:75], v18, s[40:43], s8 offen nt
  s_add_u32 s8, s8, 0x2000
  buffer_load_dwordx4 v[76:79], v18, s[40:43], s8 offen nt
  s_add_u32 s8, s8, 0x2000
  buffer_load_dwordx4 v[80:83], v18, s[40:43], s8 offen nt
  s_add_u32 s8, s8, 0x2000
  buffer_load_dwordx4 v[84:87], v18, s[40:43], s8 offen nt
  s_add_u32 s8, s8, 0x2000
  buffer_load_dwordx4 v[88:91], v18, s[40:43], s8 offen nt
  s_add_u32 s8, s8, 0x2000
  buffer_load_dwordx4 v[92:95], v18, s[40:43], s8 offen nt
  s_mov_b32 s48, s38
  s_mov_b32 s49, s39
  s_mov_b32 s50, 2097152
  s_mov_b32 s51, 0x20000
  v_lshrrev_b32 v17, 1, v2
  v_lshlrev_b32 v17, 12, v17
  v_lshl_add_u32 v17, v1, 5, v17
  v_and_b32 v16, 1, v2
  v_lshl_add_u32 v17, v16, 4, v17
  s_lshl_b32 s65, s4, 13
  s_lshl_b32 s15, s5, 9
  s_add_u32 s65, s65, s15
  v_mov_b32 v24, 0
  s_mov_b32 s10, 0x05040100
  s_mov_b32 s11, 0x07060302
  s_waitcnt vmcnt(16)
  v_lshlrev_b32 v112, 16, v4
  v_and_b32 v113, s12, v4
  v_lshlrev_b32 v114, 16, v5
  v_and_b32 v115, s12, v5
  v_lshlrev_b32 v116, 16, v6
  v_and_b32 v117, s12, v6
  v_lshlrev_b32 v118, 16, v7
  v_and_b32 v119, s12, v7
  v_lshlrev_b32 v120, 16, v8
  v_and_b32 v121, s12, v8
  v_lshlrev_b32 v122, 16, v9
  v_and_b32 v123, s12, v9
  v_lshlrev_b32 v124, 16, v10
  v_and_b32 v125, s12, v10
  v_lshlrev_b32 v126, 16, v11
  v_and_b32 v127, s12, v11
  v_add_f32 v128, v112, v113
  v_add_f32 v129, v120, v121
  v_add_f32 v130, v114, v115
  v_add_f32 v131, v122, v123
  v_add_f32 v128, v128, v116
  v_add_f32 v129, v129, v124
  v_add_f32 v130, v130, v117
  v_add_f32 v131, v131, v125
  v_add_f32 v128, v128, v118
  v_add_f32 v129, v129, v126
  v_add_f32 v130, v130, v119
  v_add_f32 v131, v131, v127
  v_add_f32 v128, v128, v130
  v_add_f32 v129, v129, v131
  s_nop 0
  v_add_f32_dpp v128, v128, v128 row_ror:8 row_mask:0xf bank_mask:0xf
  v_add_f32_dpp v129, v129, v129 row_ror:8 row_mask:0xf bank_mask:0xf
  s_nop 0
  v_add_f32_dpp v128, v128, v128 row_ror:4 row_mask:0xf bank_mask:0xf
  v_add_f32_dpp v129, v129, v129 row_ror:4 row_mask:0xf bank_mask:0xf
  s_nop 0
  v_add_f32_dpp v128, v128, v128 row_ror:2 row_mask:0xf bank_mask:0xf
  v_add_f32_dpp v129, v129, v129 row_ror:2 row_mask:0xf bank_mask:0xf
  s_nop 0
  v_add_f32_dpp v128, v128, v128 row_ror:1 row_mask:0xf bank_mask:0xf
  v_add_f32_dpp v129, v129, v129 row_ror:1 row_mask:0xf bank_mask:0xf
  v_mov_b32 v130, v128
  v_mov_b32 v131, v129
  s_nop 0
  v_permlane16_swap_b32 v128, v130
  v_permlane16_swap_b32 v129, v131
  v_add_f32 v128, v128, v130
  v_add_f32 v129, v129, v131
  v_mov_b32 v130, v128
  v_mov_b32 v131, v129
  s_nop 0
  v_permlane32_swap_b32 v128, v130
  v_permlane32_swap_b32 v129, v131
  v_add_f32 v128, v128, v130
  v_add_f32 v129, v129, v131
  v_mul_f32 v132, 0x3b000000, v128
  v_mul_f32 v133, 0x3b000000, v129
  v_sub_f32 v134, v112, v132
  v_sub_f32 v135, v120, v133
  v_mul_f32 v128, v134, v134
  v_mul_f32 v129, v135, v135
  v_sub_f32 v134, v113, v132
  v_sub_f32 v135, v121, v133
  v_fmac_f32 v128, v134, v134
  v_fmac_f32 v129, v135, v135
  v_sub_f32 v134, v114, v132
  v_sub_f32 v135, v122, v133
  v_fmac_f32 v128, v134, v134
  v_fmac_f32 v129, v135, v135
  v_sub_f32 v134, v115, v132
  v_sub_f32 v135, v123, v133
  v_fmac_f32 v128, v134, v134
  v_fmac_f32 v129, v135, v135
  v_sub_f32 v134, v116, v132
  v_sub_f32 v135, v124, v133
  v_fmac_f32 v128, v134, v134
  v_fmac_f32 v129, v135, v135
  v_sub_f32 v134, v117, v132
  v_sub_f32 v135, v125, v133
  v_fmac_f32 v128, v134, v134
  v_fmac_f32 v129, v135, v135
  v_sub_f32 v134, v118, v132
  v_sub_f32 v135, v126, v133
  v_fmac_f32 v128, v134, v134
  v_fmac_f32 v129, v135, v135
  v_sub_f32 v134, v119, v132
  v_sub_f32 v135, v127, v133
  v_fmac_f32 v128, v134, v134
  v_fmac_f32 v129, v135, v135
  s_nop 0
  v_add_f32_dpp v128, v128, v128 row_ror:8 row_mask:0xf bank_mask:0xf
  v_add_f32_dpp v129, v129, v129 row_ror:8 row_mask:0xf bank_mask:0xf
  s_nop 0
  v_add_f32_dpp v128, v128, v128 row_ror:4 row_mask:0xf bank_mask:0xf
  v_add_f32_dpp v129, v129, v129 row_ror:4 row_mask:0xf bank_mask:0xf
  s_nop 0
  v_add_f32_dpp v128, v128, v128 row_ror:2 row_mask:0xf bank_mask:0xf
  v_add_f32_dpp v129, v129, v129 row_ror:2 row_mask:0xf bank_mask:0xf
  s_nop 0
  v_add_f32_dpp v128, v128, v128 row_ror:1 row_mask:0xf bank_mask:0xf
  v_add_f32_dpp v129, v129, v129 row_ror:1 row_mask:0xf bank_mask:0xf
  v_mov_b32 v130, v128
  v_mov_b32 v131, v129
  s_nop 0
  v_permlane16_swap_b32 v128, v130
  v_permlane16_swap_b32 v129, v131
  v_add_f32 v128, v128, v130
  v_add_f32 v129, v129, v131
  v_mov_b32 v130, v128
  v_mov_b32 v131, v129
  s_nop 0
  v_permlane32_swap_b32 v128, v130
  v_permlane32_swap_b32 v129, v131
  v_add_f32 v128, v128, v130
  v_add_f32 v129, v129, v131
  v_mul_f32 v128, 0x3b000000, v128
  v_mul_f32 v129, 0x3b000000, v129
  v_cvt_pk_bf16_f32 v130, v128, v132
  v_lshlrev_b32 v128, 16, v130
  v_and_b32 v132, s12, v130
  v_cvt_pk_bf16_f32 v131, v129, v133
  v_lshlrev_b32 v129, 16, v131
  v_and_b32 v133, s12, v131
  v_add_f32 v128, 0x3727c5ac, v128
  v_add_f32 v129, 0x3727c5ac, v129
  v_cvt_pk_bf16_f32 v130, v128, v129
  v_lshlrev_b32 v128, 16, v130
  v_and_b32 v129, s12, v130
  v_sqrt_f32 v128, v128
  v_sqrt_f32 v129, v129
  s_nop 0
  v_cvt_pk_bf16_f32 v130, v128, v129
  v_lshlrev_b32 v128, 16, v130
  v_and_b32 v129, s12, v130
  v_rcp_f32 v134, v128
  v_rcp_f32 v135, v129
  v_lshlrev_b32 v12, 16, v12
  v_lshlrev_b32 v13, 16, v13
  v_sub_f32 v12, v12, v132
  v_sub_f32 v13, v13, v133
  v_cvt_pk_bf16_f32 v130, v12, v13
  v_lshlrev_b32 v12, 16, v130
  v_and_b32 v13, s12, v130
  v_mul_f32 v12, v12, v134
  v_mul_f32 v13, v13, v135
  s_nop 0
  v_mov_b32_dpp v4, v12 quad_perm:[1,1,3,3] row_mask:0xf bank_mask:0xf
  v_mov_b32_dpp v5, v13 quad_perm:[1,1,3,3] row_mask:0xf bank_mask:0xf
  v_cvt_pk_bf16_f32 v12, v12, v4
  v_cvt_pk_bf16_f32 v13, v13, v5
  s_lshl_b32 s8, s4, 13
  s_lshl_b32 s9, s6, 12
  s_add_u32 s8, s8, s9
  v_and_b32 v16, 31, v0
  v_lshlrev_b32 v16, 3, v16
  v_lshrrev_b32 v19, 5, v0
  v_lshl_add_u32 v16, v19, 2, v16
  s_waitcnt lgkmcnt(0)
  s_add_u32 s63, s63, 0x01010108
  s_andn2_b32 s54, s63, 7
  s_or_b32 s63, s54, s55
  s_and_b32 s61, s63, 0xff
  s_and_b32 s53, s54, 0xff
  s_bfe_u32 s26, s54, 0x80008
  s_bfe_u32 s27, s54, 0x80010
  s_lshr_b32 s36, s54, 24
  s_mov_b32 s60, 0xffffff00
  v_mov_b32 v31, s61
  v_mov_b32 v30, s53
  v_mov_b32 v29, s26
  v_mov_b32 v28, s27
  v_mov_b32 v27, s36
  s_cmp_lt_u32 s2, 8
  s_cbranch_scc1 L_t0pub
L_t0pd:
  s_waitcnt vmcnt(14)
  v_mov_b32_dpp v4, v12 row_newbcast:0 row_mask:0xf bank_mask:0xf
  v_mov_b32_dpp v5, v13 row_newbcast:0 row_mask:0xf bank_mask:0xf
  v_perm_b32 v112, v36, v32, s10
  v_perm_b32 v113, v36, v32, s11
  v_perm_b32 v114, v37, v33, s10
  v_perm_b32 v115, v37, v33, s11
  v_perm_b32 v116, v38, v34, s10
  v_perm_b32 v117, v38, v34, s11
  v_perm_b32 v118, v39, v35, s10
  v_perm_b32 v119, v39, v35, s11
  v_dot2_f32_bf16 v96, v112, v4, 0
  v_dot2_f32_bf16 v97, v113, v4, 0
  v_dot2_f32_bf16 v98, v114, v4, 0
  v_dot2_f32_bf16 v99, v115, v4, 0
  v_dot2_f32_bf16 v100, v116, v4, 0
  v_dot2_f32_bf16 v101, v117, v4, 0
  v_dot2_f32_bf16 v102, v118, v4, 0
  v_dot2_f32_bf16 v103, v119, v4, 0
  v_dot2_f32_bf16 v104, v112, v5, 0
  v_dot2_f32_bf16 v105, v113, v5, 0
  v_dot2_f32_bf16 v106, v114, v5, 0
  v_dot2_f32_bf16 v107, v115, v5, 0
  v_dot2_f32_bf16 v108, v116, v5, 0
  v_dot2_f32_bf16 v109, v117, v5, 0
  v_dot2_f32_bf16 v110, v118, v5, 0
  v_dot2_f32_bf16 v111, v119, v5, 0
  s_waitcnt vmcnt(12)
  v_mov_b32_dpp v6, v12 row_newbcast:2 row_mask:0xf bank_mask:0xf
  v_mov_b32_dpp v7, v13 row_newbcast:2 row_mask:0xf bank_mask:0xf
  v_perm_b32 v112, v44, v40, s10
  v_perm_b32 v113, v44, v40, s11
  v_perm_b32 v114, v45, v41, s10
  v_perm_b32 v115, v45, v41, s11
  v_perm_b32 v116, v46, v42, s10
  v_perm_b32 v117, v46, v42, s11
  v_perm_b32 v118, v47, v43, s10
  v_perm_b32 v119, v47, v43, s11
  v_dot2_f32_bf16 v96, v112, v6, v96
  v_dot2_f32_bf16 v97, v113, v6, v97
  v_dot2_f32_bf16 v98, v114, v6, v98
  v_dot2_f32_bf16 v99, v115, v6, v99
  v_dot2_f32_bf16 v100, v116, v6, v100
  v_dot2_f32_bf16 v101, v117, v6, v101
  v_dot2_f32_bf16 v102, v118, v6, v102
  v_dot2_f32_bf16 v103, v119, v6, v103
  v_dot2_f32_bf16 v104, v112, v7, v104
  v_dot2_f32_bf16 v105, v113, v7, v105
  v_dot2_f32_bf16 v106, v114, v7, v106
  v_dot2_f32_bf16 v107, v115, v7, v107
  v_dot2_f32_bf16 v108, v116, v7, v108
  v_dot2_f32_bf16 v109, v117, v7, v109
  v_dot2_f32_bf16 v110, v118, v7, v110
  v_dot2_f32_bf16 v111, v119, v7, v111
  s_waitcnt vmcnt(10)
  v_mov_b32_dpp v4, v12 row_newbcast:4 row_mask:0xf bank_mask:0xf
  v_mov_b32_dpp v5, v13 row_newbcast:4 row_mask:0xf bank_mask:0xf
  v_perm_b32 v112, v52, v48, s10
  v_perm_b32 v113, v52, v48, s11
  v_perm_b32 v114, v53, v49, s10
  v_perm_b32 v115, v53, v49, s11
  v_perm_b32 v116, v54, v50, s10
  v_perm_b32 v117, v54, v50, s11
  v_perm_b32 v118, v55, v51, s10
  v_perm_b32 v119, v55, v51, s11
  v_dot2_f32_bf16 v96, v112, v4, v96
  v_dot2_f32_bf16 v97, v113, v4, v97
  v_dot2_f32_bf16 v98, v114, v4, v98
  v_dot2_f32_bf16 v99, v115, v4, v99
  v_dot2_f32_bf16 v100, v116, v4, v100
  v_dot2_f32_bf16 v101, v117, v4, v101
  v_dot2_f32_bf16 v102, v118, v4, v102
  v_dot2_f32_bf16 v103, v119, v4, v103
  v_dot2_f32_bf16 v104, v112, v5, v104
  v_dot2_f32_bf16 v105, v113, v5, v105
  v_dot2_f32_bf16 v106, v114, v5, v106
  v_dot2_f32_bf16 v107, v115, v5, v107
  v_dot2_f32_bf16 v108, v116, v5, v108
  v_dot2_f32_bf16 v109, v117, v5, v109
  v_dot2_f32_bf16 v110, v118, v5, v110
  v_dot2_f32_bf16 v111, v119, v5, v111
  s_waitcnt vmcnt(8)
  v_mov_b32_dpp v6, v12 row_newbcast:6 row_mask:0xf bank_mask:0xf
  v_mov_b32_dpp v7, v13 row_newbcast:6 row_mask:0xf bank_mask:0xf
  v_perm_b32 v112, v60, v56, s10
  v_perm_b32 v113, v60, v56, s11
  v_perm_b32 v114, v61, v57, s10
  v_perm_b32 v115, v61, v57, s11
  v_perm_b32 v116, v62, v58, s10
  v_perm_b32 v117, v62, v58, s11
  v_perm_b32 v118, v63, v59, s10
  v_perm_b32 v119, v63, v59, s11
  v_dot2_f32_bf16 v96, v112, v6, v96
  v_dot2_f32_bf16 v97, v113, v6, v97
  v_dot2_f32_bf16 v98, v114, v6, v98
  v_dot2_f32_bf16 v99, v115, v6, v99
  v_dot2_f32_bf16 v100, v116, v6, v100
  v_dot2_f32_bf16 v101, v117, v6, v101
  v_dot2_f32_bf16 v102, v118, v6, v102
  v_dot2_f32_bf16 v103, v119, v6, v103
  v_dot2_f32_bf16 v104, v112, v7, v104
  v_dot2_f32_bf16 v105, v113, v7, v105
  v_dot2_f32_bf16 v106, v114, v7, v106
  v_dot2_f32_bf16 v107, v115, v7, v107
  v_dot2_f32_bf16 v108, v116, v7, v108
  v_dot2_f32_bf16 v109, v117, v7, v109
  v_dot2_f32_bf16 v110, v118, v7, v110
  v_dot2_f32_bf16 v111, v119, v7, v111
  s_waitcnt vmcnt(6)
  v_mov_b32_dpp v4, v12 row_newbcast:8 row_mask:0xf bank_mask:0xf
  v_mov_b32_dpp v5, v13 row_newbcast:8 row_mask:0xf bank_mask:0xf
  v_perm_b32 v112, v68, v64, s10
  v_perm_b32 v113, v68, v64, s11
  v_perm_b32 v114, v69, v65, s10
  v_perm_b32 v115, v69, v65, s11
  v_perm_b32 v116, v70, v66, s10
  v_perm_b32 v117, v70, v66, s11
  v_perm_b32 v118, v71, v67, s10
  v_perm_b32 v119, v71, v67, s11
  v_dot2_f32_bf16 v96, v112, v4, v96
  v_dot2_f32_bf16 v97, v113, v4, v97
  v_dot2_f32_bf16 v98, v114, v4, v98
  v_dot2_f32_bf16 v99, v115, v4, v99
  v_dot2_f32_bf16 v100, v116, v4, v100
  v_dot2_f32_bf16 v101, v117, v4, v101
  v_dot2_f32_bf16 v102, v118, v4, v102
  v_dot2_f32_bf16 v103, v119, v4, v103
  v_dot2_f32_bf16 v104, v112, v5, v104
  v_dot2_f32_bf16 v105, v113, v5, v105
  v_dot2_f32_bf16 v106, v114, v5, v106
  v_dot2_f32_bf16 v107, v115, v5, v107
  v_dot2_f32_bf16 v108, v116, v5, v108
  v_dot2_f32_bf16 v109, v117, v5, v109
  v_dot2_f32_bf16 v110, v118, v5, v110
  v_dot2_f32_bf16 v111, v119, v5, v111
  s_waitcnt vmcnt(4)
  v_mov_b32_dpp v6, v12 row_newbcast:10 row_mask:0xf bank_mask:0xf
  v_mov_b32_dpp v7, v13 row_newbcast:10 row_mask:0xf bank_mask:0xf
  v_perm_b32 v112, v76, v72, s10
  v_perm_b32 v113, v76, v72, s11
  v_perm_b32 v114, v77, v73, s10
  v_perm_b32 v115, v77, v73, s11
  v_perm_b32 v116, v78, v74, s10
  v_perm_b32 v117, v78, v74, s11
  v_perm_b32 v118, v79, v75, s10
  v_perm_b32 v119, v79, v75, s11
  v_dot2_f32_bf16 v96, v112, v6, v96
  v_dot2_f32_bf16 v97, v113, v6, v97
  v_dot2_f32_bf16 v98, v114, v6, v98
  v_dot2_f32_bf16 v99, v115, v6, v99
  v_dot2_f32_bf16 v100, v116, v6, v100
  v_dot2_f32_bf16 v101, v117, v6, v101
  v_dot2_f32_bf16 v102, v118, v6, v102
  v_dot2_f32_bf16 v103, v119, v6, v103
  v_dot2_f32_bf16 v104, v112, v7, v104
  v_dot2_f32_bf16 v105, v113, v7, v105
  v_dot2_f32_bf16 v106, v114, v7, v106
  v_dot2_f32_bf16 v107, v115, v7, v107
  v_dot2_f32_bf16 v108, v116, v7, v108
  v_dot2_f32_bf16 v109, v117, v7, v109
  v_dot2_f32_bf16 v110, v118, v7, v110
  v_dot2_f32_bf16 v111, v119, v7, v111
  s_waitcnt vmcnt(2)
  v_mov_b32_dpp v4, v12 row_newbcast:12 row_mask:0xf bank_mask:0xf
  v_mov_b32_dpp v5, v13 row_newbcast:12 row_mask:0xf bank_mask:0xf
  v_perm_b32 v112, v84, v80, s10
  v_perm_b32 v113, v84, v80, s11
  v_perm_b32 v114, v85, v81, s10
  v_perm_b32 v115, v85, v81, s11
  v_perm_b32 v116, v86, v82, s10
  v_perm_b32 v117, v86, v82, s11
  v_perm_b32 v118, v87, v83, s10
  v_perm_b32 v119, v87, v83, s11
  v_dot2_f32_bf16 v96, v112, v4, v96
  v_dot2_f32_bf16 v97, v113, v4, v97
  v_dot2_f32_bf16 v98, v114, v4, v98
  v_dot2_f32_bf16 v99, v115, v4, v99
  v_dot2_f32_bf16 v100, v116, v4, v100
  v_dot2_f32_bf16 v101, v117, v4, v101
  v_dot2_f32_bf16 v102, v118, v4, v102
  v_dot2_f32_bf16 v103, v119, v4, v103
  v_dot2_f32_bf16 v104, v112, v5, v104
  v_dot2_f32_bf16 v105, v113, v5, v105
  v_dot2_f32_bf16 v106, v114, v5, v106
  v_dot2_f32_bf16 v107, v115, v5, v107
  v_dot2_f32_bf16 v108, v116, v5, v108
  v_dot2_f32_bf16 v109, v117, v5, v109
  v_dot2_f32_bf16 v110, v118, v5, v110
  v_dot2_f32_bf16 v111, v119, v5, v111
  s_waitcnt vmcnt(0)
  v_mov_b32_dpp v6, v12 row_newbcast:14 row_mask:0xf bank_mask:0xf
  v_mov_b32_dpp v7, v13 row_newbcast:14 row_mask:0xf bank_mask:0xf
  v_perm_b32 v112, v92, v88, s10
  v_perm_b32 v113, v92, v88, s11
  v_perm_b32 v114, v93, v89, s10
  v_perm_b32 v115, v93, v89, s11
  v_perm_b32 v116, v94, v90, s10
  v_perm_b32 v117, v94, v90, s11
  v_perm_b32 v118, v95, v91, s10
  v_perm_b32 v119, v95, v91, s11
  v_dot2_f32_bf16 v96, v112, v6, v96
  v_dot2_f32_bf16 v97, v113, v6, v97
  v_dot2_f32_bf16 v98, v114, v6, v98
  v_dot2_f32_bf16 v99, v115, v6, v99
  v_dot2_f32_bf16 v100, v116, v6, v100
  v_dot2_f32_bf16 v101, v117, v6, v101
  v_dot2_f32_bf16 v102, v118, v6, v102
  v_dot2_f32_bf16 v103, v119, v6, v103
  v_dot2_f32_bf16 v104, v112, v7, v104
  v_dot2_f32_bf16 v105, v113, v7, v105
  v_dot2_f32_bf16 v106, v114, v7, v106
  v_dot2_f32_bf16 v107, v115, v7, v107
  v_dot2_f32_bf16 v108, v116, v7, v108
  v_dot2_f32_bf16 v109, v117, v7, v109
  v_dot2_f32_bf16 v110, v118, v7, v110
  v_dot2_f32_bf16 v111, v119, v7, v111
  v_permlane32_swap_b32 v96, v104
  v_permlane32_swap_b32 v97, v105
  v_permlane32_swap_b32 v98, v106
  v_permlane32_swap_b32 v99, v107
  v_permlane32_swap_b32 v100, v108
  v_permlane32_swap_b32 v101, v109
  v_permlane32_swap_b32 v102, v110
  v_permlane32_swap_b32 v103, v111
  v_add_f32 v96, v96, v104
  v_add_f32 v97, v97, v105
  v_add_f32 v98, v98, v106
  v_add_f32 v99, v99, v107
  v_add_f32 v100, v100, v108
  v_add_f32 v101, v101, v109
  v_add_f32 v102, v102, v110
  v_add_f32 v103, v103, v111
  v_permlane16_swap_b32 v96, v100
  v_permlane16_swap_b32 v97, v101
  v_permlane16_swap_b32 v98, v102
  v_permlane16_swap_b32 v99, v103
  v_add_f32 v96, v96, v100
  v_add_f32 v97, v97, v101
  v_add_f32 v98, v98, v102
  v_add_f32 v99, v99, v103
  v_and_or_b32 v96, v96, s60, v31
  v_and_or_b32 v97, v97, s60, v29
  v_and_or_b32 v98, v98, s60, v28
  v_and_or_b32 v99, v99, s60, v27
  buffer_store_dwordx4 v[96:99], v17, s[48:51], s65 offen
  s_mov_b32 s52, 0
  s_mov_b32 s14, 0
L_q_poll:
  buffer_load_dwordx4 v[32:35], v3, s[48:51], s8 offen offset:0 sc1
  buffer_load_dwordx4 v[36:39], v3, s[48:51], s8 offen offset:1024 sc1
  buffer_load_dwordx4 v[40:43], v3, s[48:51], s8 offen offset:2048 sc1
  buffer_load_dwordx4 v[44:47], v3, s[48:51], s8 offen offset:3072 sc1
  s_waitcnt vmcnt(0)
  v_xor_b32 v32, s61, v32
  v_xor_b32 v33, s26, v33
  v_xor_b32 v34, s27, v34
  v_xor_b32 v35, s36, v35
  v_xor_b32 v36, s61, v36
  v_xor_b32 v37, s26, v37
  v_xor_b32 v38, s27, v38
  v_xor_b32 v39, s36, v39
  v_xor_b32 v40, s61, v40
  v_xor_b32 v41, s26, v41
  v_xor_b32 v42, s27, v42
  v_xor_b32 v43, s36, v43
  v_xor_b32 v44, s61, v44
  v_xor_b32 v45, s26, v45
  v_xor_b32 v46, s27, v46
  v_xor_b32 v47, s36, v47
  v_or3_b32 v48, v32, v33, v34
  v_or3_b32 v48, v48, v35, v36
  v_or3_b32 v48, v48, v37, v38
  v_or3_b32 v48, v48, v39, v40
  v_or3_b32 v48, v48, v41, v42
  v_or3_b32 v48, v48, v43, v44
  v_or3_b32 v48, v48, v45, v46
  v_or3_b32 v48, v48, v47, v47
  v_and_b32 v48, 0xff, v48
  v_cmp_ne_u32 vcc, 0, v48
  s_cbranch_vccz L_q_go
  s_sleep 4
  s_add_u32 s14, s14, 1
  s_cmp_lt_u32 s14, 24
  s_cbranch_scc1 L_q_poll
  s_branch L_q_slow
L_q_go:
  v_add_f32 v32, v32, v36
  v_add_f32 v33, v33, v37
  v_add_f32 v34, v34, v38
  v_add_f32 v35, v35, v39
  v_add_f32 v32, v32, v40
  v_add_f32 v33, v33, v41
  v_add_f32 v34, v34, v42
  v_add_f32 v35, v35, v43
  v_add_f32 v32, v32, v44
  v_add_f32 v33, v33, v45
  v_add_f32 v34, v34, v46
  v_add_f32 v35, v35, v47
  s_nop 0
  v_permlane32_swap_b32 v32, v34
  v_permlane32_swap_b32 v33, v35
  v_add_f32 v32, v32, v34
  v_add_f32 v33, v33, v35
  v_cvt_pk_bf16_f32 v32, v32, v33
  v_min_u32 v32, 0xfffffffe, v32
  ds_write_b32 v16, v32 offset:0
  v_and_b32 v16, 7, v0
  v_lshlrev_b32 v16, 3, v16
  s_mov_b32 s9, 1016832
  buffer_load_dwordx2 v[4:5], v16, s[48:51], s9 offen sc1
  s_setprio 1
  s_mov_b32 s40, s24
  s_mov_b32 s41, s25
  s_mov_b32 s42, 4194304
  s_mov_b32 s43, 0x20000
  v_lshlrev_b32 v18, 13, v2
  v_lshl_add_u32 v18, v1, 3, v18
  s_lshl_b32 s66, s4, 17
  s_add_u32 s66, s66, s13
  v_lshrrev_b32 v15, 3, v0
  v_lshlrev_b32 v15, 8, v15
  v_and_b32 v16, 7, v0
  v_lshl_add_u32 v15, v16, 3, v15
  v_lshrrev_b32 v16, 1, v2
  v_and_b32 v14, 11, v0
  v_lshl_add_u32 v16, v16, 2, v14
  v_and_b32 v14, 1, v2
  v_lshlrev_b32 v22, 10, v14
  v_lshl_add_u32 v22, v16, 3, v22
  v_add_u32 v22, s13, v22
  v_lshlrev_b32 v14, 9, v14
  v_lshl_add_u32 v14, v16, 5, v14
  buffer_load_dwordx2 v[84:85], v22, s[56:59], 0 offen
  s_lshl_b32 s67, s4, 7
  s_add_u32 s67, s67, 655360
  s_add_u32 s67, s67, s52
  s_lshl_b32 s62, s5, 4
  s_add_u32 s62, s62, s67
  s_lshl_b32 s9, s6, 6
  s_add_u32 s67, s67, s9
  v_and_b32 v23, 3, v0
  v_lshlrev_b32 v23, 4, v23
  v_lshrrev_b32 v19, 5, v0
  v_lshlrev_b32 v19, 11, v19
  v_and_b32 v20, 31, v0
  v_lshl_add_u32 v19, v20, 4, v19
  v_lshlrev_b32 v20, 3, v0
  v_bfe_u32 v21, v0, 2, 1
  v_lshlrev_b32 v21, 8, v21
  v_lshl_add_u32 v21, v2, 4, v21
  s_waitcnt vmcnt(0)
  v_cmp_ne_u32 vcc, s54, v5
  v_subrev_u32 v4, s46, v4
  v_min_i32 v4, 200, v4
  v_max_i32 v4, -200, v4
  s_or_b32 s33, vcc_lo, vcc_hi
  s_cbranch_vccnz L_t0no
  v_add_u32_dpp v4, v4, v4 row_ror:4 row_mask:0xf bank_mask:0xf
  s_nop 1
  v_add_u32_dpp v4, v4, v4 row_ror:2 row_mask:0xf bank_mask:0xf
  s_nop 1
  v_add_u32_dpp v4, v4, v4 row_ror:1 row_mask:0xf bank_mask:0xf
  v_ashrrev_i32 v4, 3, v4
  v_add_u32 v4, s46, v4
  v_min_u32 v4, 0xfffffffe, v4
  ds_write_b32 v24, v4 offset:384
  v_readfirstlane_b32 s46, v4
L_t0no:
  s_mov_b32 s14, 2097152
L_ml_poll:
  s_sleep 4
  ds_read_b128 v[32:35], v24 offset:256
  ds_read_b128 v[36:39], v24 offset:272
  ds_read_b128 v[40:43], v24 offset:288
  ds_read_b128 v[44:47], v24 offset:304
  s_sub_u32 s14, s14, 1
  s_cbranch_scc1 L_ml_go
  s_waitcnt lgkmcnt(0)
  v_add_f32 v48, v33, v35
  v_add_f32 v48, v48, v37
  v_add_f32 v48, v48, v39
  v_add_f32 v48, v48, v41
  v_add_f32 v48, v48, v43
  v_add_f32 v48, v48, v45
  v_add_f32 v48, v48, v47
  v_cmp_u_f32 vcc, v48, v48
  s_cbranch_vccnz L_ml_poll
L_ml_go:
  s_waitcnt lgkmcnt(0)
  v_mul_f32 v32, 0x3fb8aa3b, v32
  v_mul_f32 v34, 0x3fb8aa3b, v34
  v_mul_f32 v36, 0x3fb8aa3b, v36
  v_mul_f32 v38, 0x3fb8aa3b, v38
  v_mul_f32 v40, 0x3fb8aa3b, v40
  v_mul_f32 v42, 0x3fb8aa3b, v42
  v_mul_f32 v44, 0x3fb8aa3b, v44
  v_mul_f32 v46, 0x3fb8aa3b, v46
  v_max3_f32 v48, v32, v34, v36
  v_max3_f32 v48, v48, v38, v40
  v_max3_f32 v48, v48, v42, v44
  v_max_f32 v48, v48, v46
  v_sub_f32 v52, v32, v48
  v_sub_f32 v53, v34, v48
  v_sub_f32 v54, v36, v48
  v_sub_f32 v55, v38, v48
  v_sub_f32 v56, v40, v48
  v_sub_f32 v57, v42, v48
  v_sub_f32 v58, v44, v48
  v_sub_f32 v59, v46, v48
  v_exp_f32 v52, v52
  v_exp_f32 v53, v53
  v_exp_f32 v54, v54
  v_exp_f32 v55, v55
  v_exp_f32 v56, v56
  v_exp_f32 v57, v57
  v_exp_f32 v58, v58
  v_exp_f32 v59, v59
  v_mov_b32 v49, s63
  v_mov_b32 v51, s63
  v_mul_f32 v50, v52, v33
  v_fmac_f32 v50, v53, v35
  v_fmac_f32 v50, v54, v37
  v_fmac_f32 v50, v55, v39
  v_fmac_f32 v50, v56, v41
  v_fmac_f32 v50, v57, v43
  v_fmac_f32 v50, v58, v45
  v_fmac_f32 v50, v59, v47
  s_mov_b64 exec, 1
  s_cmp_lg_u32 s52, 0
  s_cbranch_scc1 L_h_sst
  buffer_store_dwordx4 v[48:51], v24, s[48:51], s62 offen
L_h_std:
  s_mov_b64 exec, -1
  s_mov_b32 s14, 262144
L_h_poll:
  s_sleep 16
  buffer_load_dwordx4 v[4:7], v23, s[48:51], s67 offen sc1
  s_waitcnt vmcnt(0)
  v_xor_b32 v5, s63, v5
  v_xor_b32 v7, s63, v7
  v_or_b32 v5, v5, v7
  v_cmp_ne_u32 vcc, 0, v5
  s_cbranch_vccz L_h_go
  s_sub_u32 s14, s14, 1
  s_cbranch_scc0 L_h_poll
L_h_go:
  v_max_f32_dpp v8, v4, v4 quad_perm:[1,0,3,2] row_mask:0xf bank_mask:0xf
  s_nop 1
  v_max_f32_dpp v8, v8, v8 quad_perm:[2,3,0,1] row_mask:0xf bank_mask:0xf
  v_sub_f32 v4, v4, v8
  v_exp_f32 v4, v4
  v_sub_f32 v52, v32, v8
  v_sub_f32 v53, v34, v8
  v_sub_f32 v54, v36, v8
  v_sub_f32 v55, v38, v8
  v_sub_f32 v56, v40, v8
  v_sub_f32 v57, v42, v8
  v_sub_f32 v58, v44, v8
  v_sub_f32 v59, v46, v8
  v_mul_f32 v4, v4, v6
  v_exp_f32 v52, v52
  v_exp_f32 v53, v53
  v_exp_f32 v54, v54
  v_exp_f32 v55, v55
  v_exp_f32 v56, v56
  v_exp_f32 v57, v57
  v_exp_f32 v58, v58
  v_exp_f32 v59, v59
  v_add_f32_dpp v4, v4, v4 quad_perm:[1,0,3,2] row_mask:0xf bank_mask:0xf
  s_nop 1
  v_add_f32_dpp v4, v4, v4 quad_perm:[2,3,0,1] row_mask:0xf bank_mask:0xf
  v_rcp_f32 v4, v4
  s_nop 0
  v_mul_f32 v52, v52, v4
  v_mul_f32 v53, v53, v4
  v_mul_f32 v54, v54, v4
  v_mul_f32 v55, v55, v4
  v_mul_f32 v56, v56, v4
  v_mul_f32 v57, v57, v4
  v_mul_f32 v58, v58, v4
  v_mul_f32 v59, v59, v4
  s_lshl_b32 s8, s4, 12
  s_add_u32 s8, s8, 524288
  s_add_u32 s8, s8, s52
  s_lshl_b32 s9, s5, 9
  s_add_u32 s9, s9, s8
  s_mov_b32 s65, 720896
  s_mov_b32 s44, 0xaaaaaaaa
  s_mov_b32 s45, 0xaaaaaaaa
  v_cndmask_b32 v25, v31, v28, s[44:45]
  v_cndmask_b32 v26, v29, v27, s[44:45]
  s_mov_b32 s15, s46
  s_mov_b32 s44, s34
  s_mov_b32 s45, s35
  s_mov_b32 s46, 2048
  s_mov_b32 s47, 0x20000
  s_lshl_b32 s65, s5, 9
  s_add_u32 s67, s65, 884736
  s_lshl_b32 s65, s5, 12
  s_add_u32 s65, s65, 851968
  s_mov_b32 s68, 0
  s_mov_b32 s69, 0x41b80000
  s_and_b32 s62, s54, 0xffff
  v_lshlrev_b32 v82, 16, v84
  v_and_b32 v83, s12, v84
  v_lshlrev_b32 v84, 16, v85
  v_and_b32 v85, s12, v85
  s_cmp_lg_u32 s33, 0
  s_cbranch_scc1 L_acw
L_acwd:
  s_mov_b32 s33, 0xbfb80000
  v_mov_b32 v86, s54
  v_mov_b32 v87, 1015808
  s_mov_b32 s67, 0xc2480000
  s_mov_b32 s37, 0xc3b80000
  s_mov_b32 s62, 0x7c000000
  s_mov_b32 s34, 0x0f0f0f0f
  s_mov_b32 s35, 0x0f0f0f0f
  s_setprio 3
  s_barrier
  buffer_load_dwordx2 v[104:105], v18, s[40:43], s66 offen offset:0 nt
  buffer_load_dwordx2 v[106:107], v18, s[40:43], s66 offen offset:1024 nt
  buffer_load_dwordx2 v[108:109], v18, s[40:43], s66 offen offset:2048 nt
  buffer_load_dwordx2 v[110:111], v18, s[40:43], s66 offen offset:3072 nt
  s_add_u32 s66, s66, 0x1000
  buffer_load_dwordx2 v[112:113], v18, s[40:43], s66 offen offset:0 nt
  buffer_load_dwordx2 v[114:115], v18, s[40:43], s66 offen offset:1024 nt
  buffer_load_dwordx2 v[116:117], v18, s[40:43], s66 offen offset:2048 nt
  buffer_load_dwordx2 v[118:119], v18, s[40:43], s66 offen offset:3072 nt
  s_add_u32 s66, s66, 0x7000
  buffer_load_dwordx2 v[120:121], v18, s[40:43], s66 offen offset:0 nt
  buffer_load_dwordx2 v[122:123], v18, s[40:43], s66 offen offset:1024 nt
  buffer_load_dwordx2 v[124:125], v18, s[40:43], s66 offen offset:2048 nt
  buffer_load_dwordx2 v[126:127], v18, s[40:43], s66 offen offset:3072 nt
  s_add_u32 s66, s66, 0x1000
  buffer_load_dwordx2 v[128:129], v18, s[40:43], s66 offen offset:0 nt
  buffer_load_dwordx2 v[130:131], v18, s[40:43], s66 offen offset:1024 nt
  buffer_load_dwordx2 v[132:133], v18, s[40:43], s66 offen offset:2048 nt
  buffer_load_dwordx2 v[134:135], v18, s[40:43], s66 offen offset:3072 nt
  s_add_u32 s66, s66, 0x7000
  buffer_load_dwordx2 v[136:137], v18, s[40:43], s66 offen offset:0 nt
  buffer_load_dwordx2 v[138:139], v18, s[40:43], s66 offen offset:1024 nt
  buffer_load_dwordx2 v[140:141], v18, s[40:43], s66 offen offset:2048 nt
  buffer_load_dwordx2 v[142:143], v18, s[40:43], s66 offen offset:3072 nt
  s_add_u32 s66, s66, 0x1000
  buffer_load_dwordx2 v[144:145], v18, s[40:43], s66 offen offset:0 nt
  buffer_load_dwordx2 v[146:147], v18, s[40:43], s66 offen offset:1024 nt
  buffer_load_dwordx2 v[148:149], v18, s[40:43], s66 offen offset:2048 nt
  buffer_load_dwordx2 v[150:151], v18, s[40:43], s66 offen offset:3072 nt
  s_add_u32 s66, s66, 0x7000
  buffer_load_dwordx2 v[152:153], v18, s[40:43], s66 offen offset:0 nt
  buffer_load_dwordx2 v[154:155], v18, s[40:43], s66 offen offset:1024 nt
  buffer_load_dwordx2 v[156:157], v18, s[40:43], s66 offen offset:2048 nt
  buffer_load_dwordx2 v[158:159], v18, s[40:43], s66 offen offset:3072 nt
  s_add_u32 s66, s66, 0x1000
  buffer_load_dwordx2 v[160:161], v18, s[40:43], s66 offen offset:0 nt
  buffer_load_dwordx2 v[162:163], v18, s[40:43], s66 offen offset:1024 nt
  buffer_load_dwordx2 v[164:165], v18, s[40:43], s66 offen offset:2048 nt
  buffer_load_dwordx2 v[166:167], v18, s[40:43], s66 offen offset:3072 nt
  s_barrier
  ds_read_b64 v[60:61], v20 offset:512
  ds_read_b64 v[62:63], v20 offset:1024
  ds_read_b64 v[64:65], v20 offset:1536
  ds_read_b64 v[66:67], v20 offset:2048
  ds_read_b64 v[68:69], v20 offset:2560
  ds_read_b64 v[70:71], v20 offset:3072
  ds_read_b64 v[72:73], v20 offset:3584
  ds_read_b64 v[74:75], v20 offset:4096
  s_waitcnt lgkmcnt(7)
  v_mul_f32 v80, v52, v60
  v_mul_f32 v81, v52, v61
  s_waitcnt lgkmcnt(6)
  v_fmac_f32 v80, v53, v62
  v_fmac_f32 v81, v53, v63
  s_waitcnt lgkmcnt(5)
  v_fmac_f32 v80, v54, v64
  v_fmac_f32 v81, v54, v65
  s_waitcnt lgkmcnt(4)
  v_fmac_f32 v80, v55, v66
  v_fmac_f32 v81, v55, v67
  s_waitcnt lgkmcnt(3)
  v_fmac_f32 v80, v56, v68
  v_fmac_f32 v81, v56, v69
  s_waitcnt lgkmcnt(2)
  v_fmac_f32 v80, v57, v70
  v_fmac_f32 v81, v57, v71
  s_waitcnt lgkmcnt(1)
  v_fmac_f32 v80, v58, v72
  v_fmac_f32 v81, v58, v73
  s_waitcnt lgkmcnt(0)
  v_fmac_f32 v80, v59, v74
  v_fmac_f32 v81, v59, v75
  v_and_or_b32 v80, v80, s60, v25
  v_and_or_b32 v81, v81, s60, v26
  s_cmp_lg_u32 s52, 0
  s_cbranch_scc1 L_o_sst
  buffer_store_dwordx2 v[80:81], v20, s[48:51], s9 offen
L_o_std:
  s_waitcnt vmcnt(17)
  s_mov_b32 s14, 262144
  buffer_load_dwordx4 v[32:35], v19, s[48:51], s8 offen offset:0 sc1
  buffer_load_dwordx4 v[36:39], v19, s[48:51], s8 offen offset:512 sc1
  buffer_load_dwordx4 v[40:43], v19, s[48:51], s8 offen offset:1024 sc1
  buffer_load_dwordx4 v[44:47], v19, s[48:51], s8 offen offset:1536 sc1
  s_waitcnt vmcnt(29)
  v_perm_b32 v88, v106, v104, s10
  v_perm_b32 v89, v110, v108, s10
  v_perm_b32 v90, v114, v112, s10
  v_perm_b32 v91, v118, v116, s10
  v_perm_b32 v92, v106, v104, s11
  v_perm_b32 v93, v110, v108, s11
  v_perm_b32 v94, v114, v112, s11
  v_perm_b32 v95, v118, v116, s11
  v_perm_b32 v96, v107, v105, s10
  v_perm_b32 v97, v111, v109, s10
  v_perm_b32 v98, v115, v113, s10
  v_perm_b32 v99, v119, v117, s10
  v_perm_b32 v100, v107, v105, s11
  v_perm_b32 v101, v111, v109, s11
  v_perm_b32 v102, v115, v113, s11
  v_perm_b32 v103, v119, v117, s11
  s_waitcnt vmcnt(21)
  v_perm_b32 v104, v122, v120, s10
  v_perm_b32 v105, v126, v124, s10
  v_perm_b32 v106, v130, v128, s10
  v_perm_b32 v107, v134, v132, s10
  v_perm_b32 v108, v122, v120, s11
  v_perm_b32 v109, v126, v124, s11
  v_perm_b32 v110, v130, v128, s11
  v_perm_b32 v111, v134, v132, s11
  v_perm_b32 v112, v123, v121, s10
  v_perm_b32 v113, v127, v125, s10
  v_perm_b32 v114, v131, v129, s10
  v_perm_b32 v115, v135, v133, s10
  v_perm_b32 v116, v123, v121, s11
  v_perm_b32 v117, v127, v125, s11
  v_perm_b32 v118, v131, v129, s11
  v_perm_b32 v119, v135, v133, s11
  s_waitcnt vmcnt(13)
  v_perm_b32 v120, v138, v136, s10
  v_perm_b32 v121, v142, v140, s10
  v_perm_b32 v122, v146, v144, s10
  v_perm_b32 v123, v150, v148, s10
  v_perm_b32 v124, v138, v136, s11
  v_perm_b32 v125, v142, v140, s11
  v_perm_b32 v126, v146, v144, s11
  v_perm_b32 v127, v150, v148, s11
  v_perm_b32 v128, v139, v137, s10
  v_perm_b32 v129, v143, v141, s10
  v_perm_b32 v130, v147, v145, s10
  v_perm_b32 v131, v151, v149, s10
  v_perm_b32 v132, v139, v137, s11
  v_perm_b32 v133, v143, v141, s11
  v_perm_b32 v134, v147, v145, s11
  v_perm_b32 v135, v151, v149, s11
  s_waitcnt vmcnt(5)
  v_perm_b32 v136, v154, v152, s10
  v_perm_b32 v137, v158, v156, s10
  v_perm_b32 v138, v162, v160, s10
  v_perm_b32 v139, v166, v164, s10
  v_perm_b32 v140, v154, v152, s11
  v_perm_b32 v141, v158, v156, s11
  v_perm_b32 v142, v162, v160, s11
  v_perm_b32 v143, v166, v164, s11
  v_perm_b32 v144, v155, v153, s10
  v_perm_b32 v145, v159, v157, s10
  v_perm_b32 v146, v163, v161, s10
  v_perm_b32 v147, v167, v165, s10
  v_perm_b32 v148, v155, v153, s11
  v_perm_b32 v149, v159, v157, s11
  v_perm_b32 v150, v163, v161, s11
  v_perm_b32 v151, v167, v165, s11
  ds_read_b128 v[152:155], v14 offset:6144
  ds_read_b128 v[156:159], v14 offset:6160
  ds_read_b128 v[160:163], v14 offset:7168
  ds_read_b128 v[164:167], v14 offset:7184
  s_branch L_o_chk
L_o_poll:
  buffer_load_dwordx4 v[32:35], v19, s[48:51], s8 offen offset:0 sc1
  buffer_load_dwordx4 v[36:39], v19, s[48:51], s8 offen offset:512 sc1
  buffer_load_dwordx4 v[40:43], v19, s[48:51], s8 offen offset:1024 sc1
  buffer_load_dwordx4 v[44:47], v19, s[48:51], s8 offen offset:1536 sc1
L_o_chk:
  s_waitcnt vmcnt(3)
  v_xor_b32 v32, s61, v32
  v_xor_b32 v33, s26, v33
  v_xor_b32 v34, s27, v34
  v_xor_b32 v35, s36, v35
  s_waitcnt vmcnt(2)
  v_xor_b32 v36, s61, v36
  v_xor_b32 v37, s26, v37
  v_xor_b32 v38, s27, v38
  v_xor_b32 v39, s36, v39
  v_add_f32 v4, v32, v36
  v_add_f32 v5, v33, v37
  v_add_f32 v6, v34, v38
  v_add_f32 v7, v35, v39
  s_waitcnt vmcnt(1)
  v_xor_b32 v40, s61, v40
  v_xor_b32 v41, s26, v41
  v_xor_b32 v42, s27, v42
  v_xor_b32 v43, s36, v43
  v_add_f32 v4, v4, v40
  v_add_f32 v5, v5, v41
  v_add_f32 v6, v6, v42
  v_add_f32 v7, v7, v43
  s_waitcnt vmcnt(0)
  v_xor_b32 v44, s61, v44
  v_xor_b32 v45, s26, v45
  v_xor_b32 v46, s27, v46
  v_xor_b32 v47, s36, v47
  v_add_f32 v4, v4, v44
  v_add_f32 v5, v5, v45
  v_add_f32 v6, v6, v46
  v_add_f32 v7, v7, v47
  v_cvt_pk_bf16_f32 v4, v4, v5
  v_cvt_pk_bf16_f32 v5, v6, v7
  ds_write_b64 v20, v[4:5] offset:5120
  ds_read_b128 v[48:51], v21 offset:5120
  ds_read_b128 v[52:55], v21 offset:5184
  ds_read_b128 v[56:59], v21 offset:5248
  ds_read_b128 v[60:63], v21 offset:5312
  v_or3_b32 v12, v32, v33, v34
  v_or3_b32 v12, v12, v35, v36
  v_or3_b32 v12, v12, v37, v38
  v_or3_b32 v12, v12, v39, v40
  v_or3_b32 v12, v12, v41, v42
  v_or3_b32 v12, v12, v43, v44
  v_or3_b32 v12, v12, v45, v46
  v_or3_b32 v12, v12, v47, v47
  v_and_b32 v12, 0xff, v12
  v_cmp_ne_u32 vcc, 0, v12
  s_cbranch_vccz L_o_go
  s_sub_u32 s14, s14, 1
  s_cbranch_scc0 L_o_poll
L_o_go:
  s_waitcnt lgkmcnt(3)
  v_mfma_f32_16x16x32_bf16 v[64:67], v[48:51], v[88:91], 0
  v_mfma_f32_16x16x32_bf16 v[68:71], v[48:51], v[92:95], 0
  v_mfma_f32_16x16x32_bf16 v[72:75], v[48:51], v[96:99], 0
  v_mfma_f32_16x16x32_bf16 v[76:79], v[48:51], v[100:103], 0
  s_waitcnt lgkmcnt(2)
  v_mfma_f32_16x16x32_bf16 v[64:67], v[52:55], v[104:107], v[64:67]
  v_mfma_f32_16x16x32_bf16 v[68:71], v[52:55], v[108:111], v[68:71]
  v_mfma_f32_16x16x32_bf16 v[72:75], v[52:55], v[112:115], v[72:75]
  v_mfma_f32_16x16x32_bf16 v[76:79], v[52:55], v[116:119], v[76:79]
  s_waitcnt lgkmcnt(1)
  v_mfma_f32_16x16x32_bf16 v[64:67], v[56:59], v[120:123], v[64:67]
  v_mfma_f32_16x16x32_bf16 v[68:71], v[56:59], v[124:127], v[68:71]
  v_mfma_f32_16x16x32_bf16 v[72:75], v[56:59], v[128:131], v[72:75]
  v_mfma_f32_16x16x32_bf16 v[76:79], v[56:59], v[132:135], v[76:79]
  s_waitcnt lgkmcnt(0)
  v_mfma_f32_16x16x32_bf16 v[64:67], v[60:63], v[136:139], v[64:67]
  v_mfma_f32_16x16x32_bf16 v[68:71], v[60:63], v[140:143], v[68:71]
  v_mfma_f32_16x16x32_bf16 v[72:75], v[60:63], v[144:147], v[72:75]
  v_mfma_f32_16x16x32_bf16 v[76:79], v[60:63], v[148:151], v[76:79]
  s_nop 4
  v_mov_b32_dpp v64, v64 row_shl:4 row_mask:0xc bank_mask:0x5
  v_mov_b32_dpp v68, v68 row_shl:4 row_mask:0xc bank_mask:0x5
  v_mov_b32_dpp v72, v72 row_shl:4 row_mask:0xc bank_mask:0x5
  v_mov_b32_dpp v76, v76 row_shl:4 row_mask:0xc bank_mask:0x5
  s_mov_b64 exec, s[34:35]
  v_cvt_f64_f32 v[32:33], v64
  v_cvt_f64_f32 v[34:35], v68
  v_cvt_f64_f32 v[36:37], v72
  v_cvt_f64_f32 v[38:39], v76
  v_add_f64 v[152:153], v[32:33], s[68:69]
  v_add_f64 v[154:155], v[34:35], s[68:69]
  v_add_f64 v[156:157], v[36:37], s[68:69]
  v_add_f64 v[158:159], v[38:39], s[68:69]
  v_add_u32 v153, s67, v153
  v_add_u32 v155, s67, v155
  v_add_u32 v157, s67, v157
  v_add_u32 v159, s67, v159
  s_mov_b64 exec, -1
  buffer_atomic_add_x2 v[152:153], v15, s[48:51], s65 offen offset:0 sc0 sc1
  buffer_atomic_add_x2 v[154:155], v15, s[48:51], s65 offen offset:128 sc0 sc1
  buffer_atomic_add_x2 v[156:157], v15, s[48:51], s65 offen offset:2048 sc0 sc1
  buffer_atomic_add_x2 v[158:159], v15, s[48:51], s65 offen offset:2176 sc0 sc1
  s_mov_b64 exec, s[34:35]
  v_add_f64 v[160:161], v[32:33], -s[68:69]
  v_add_f64 v[162:163], v[34:35], -s[68:69]
  v_add_f64 v[164:165], v[36:37], -s[68:69]
  v_add_f64 v[166:167], v[38:39], -s[68:69]
  s_mov_b64 exec, -1
  s_waitcnt vmcnt(3)
  v_cmp_le_u32 s[16:17], s62, v153
  v_add_u32 v153, s37, v153
  v_add_f64 v[152:153], v[152:153], v[160:161]
  v_cvt_f32_f64 v4, v[152:153]
  s_waitcnt vmcnt(2)
  v_cmp_le_u32 s[18:19], s62, v155
  v_add_u32 v155, s37, v155
  v_add_f64 v[154:155], v[154:155], v[162:163]
  v_cvt_f32_f64 v5, v[154:155]
  s_waitcnt vmcnt(1)
  v_cmp_le_u32 s[20:21], s62, v157
  v_add_u32 v157, s37, v157
  v_add_f64 v[156:157], v[156:157], v[164:165]
  s_or_b64 vcc, s[16:17], s[18:19]
  v_cvt_f32_f64 v6, v[156:157]
  s_waitcnt vmcnt(0)
  v_cmp_le_u32 s[22:23], s62, v159
  v_add_u32 v159, s37, v159
  v_add_f64 v[158:159], v[158:159], v[166:167]
  s_or_b64 vcc, vcc, s[20:21]
  v_cvt_f32_f64 v7, v[158:159]
  s_or_b64 vcc, vcc, s[22:23]
  s_cbranch_scc0 L_at_end
  v_cvt_pk_bf16_f32 v8, v4, v5
  v_lshlrev_b32 v4, 16, v8
  v_and_b32 v5, s12, v8
  v_cvt_pk_bf16_f32 v9, v6, v7
  v_lshlrev_b32 v6, 16, v9
  v_and_b32 v7, s12, v9
  v_add_f32 v8, v82, v4
  v_add_f32 v9, v83, v5
  v_add_f32 v10, v84, v6
  v_add_f32 v11, v85, v7
  v_cvt_pk_bf16_f32 v12, v8, v9
  v_lshlrev_b32 v8, 16, v12
  v_and_b32 v9, s12, v12
  v_cvt_pk_bf16_f32 v13, v10, v11
  v_lshlrev_b32 v10, 16, v13
  v_and_b32 v11, s12, v13
  v_add_f32_dpp v8, v4, v8 row_shl:4 row_mask:0xf bank_mask:0x5
  v_add_f32_dpp v9, v5, v9 row_shl:4 row_mask:0xf bank_mask:0x5
  v_add_f32_dpp v10, v6, v10 row_shl:4 row_mask:0xf bank_mask:0x5
  v_add_f32_dpp v11, v7, v11 row_shl:4 row_mask:0xf bank_mask:0x5
  v_cvt_pk_bf16_f32 v8, v8, v9
  v_cvt_pk_bf16_f32 v10, v10, v11
  s_and_b64 exec, s[22:23], s[34:35]
  s_cbranch_scc0 L_at_s3
  buffer_store_short_d16_hi v10, v22, s[44:47], 0 offen offset:6
L_at_s3:
  s_and_b64 exec, s[20:21], s[34:35]
  s_cbranch_scc0 L_at_s2
  buffer_store_short v10, v22, s[44:47], 0 offen offset:4
L_at_s2:
  s_and_b64 exec, s[18:19], s[34:35]
  s_cbranch_scc0 L_at_s1
  buffer_store_short_d16_hi v8, v22, s[44:47], 0 offen offset:2
L_at_s1:
  s_and_b64 exec, s[16:17], s[34:35]
  s_cbranch_scc0 L_at_s0
  buffer_store_short v8, v22, s[44:47], 0 offen offset:0
L_at_s0:
  s_mov_b64 s[24:25], 0
  s_lshr_b64 s[26:27], s[16:17], 4
  s_andn2_b64 s[26:27], s[16:17], s[26:27]
  s_or_b64 s[24:25], s[24:25], s[26:27]
  s_lshr_b64 s[26:27], s[18:19], 4
  s_andn2_b64 s[26:27], s[18:19], s[26:27]
  s_or_b64 s[24:25], s[24:25], s[26:27]
  s_lshr_b64 s[26:27], s[20:21], 4
  s_andn2_b64 s[26:27], s[20:21], s[26:27]
  s_or_b64 s[24:25], s[24:25], s[26:27]
  s_lshr_b64 s[26:27], s[22:23], 4
  s_andn2_b64 s[26:27], s[22:23], s[26:27]
  s_or_b64 s[24:25], s[24:25], s[26:27]
  s_and_b64 s[24:25], s[24:25], s[34:35]
  s_cbranch_scc1 L_bre
L_bred:
  s_cmp_lg_u32 s5, 0
  s_cbranch_scc1 L_at_end
  s_and_b64 exec, s[16:17], 1
  s_cbranch_scc0 L_at_end
  buffer_store_dword v86, v87, s[48:51], 0 offen sc1
L_at_end:
  s_endpgm
L_hf:
  s_setprio 1
  s_load_dword s63, s[38:39], 1015808
  s_getreg_b32 s55, hwreg(HW_REG_XCC_ID, 0, 3)
  s_mov_b32 s56, s16
  s_mov_b32 s57, s17
  s_mov_b32 s58, 2048
  s_mov_b32 s59, 0x20000
  s_mov_b32 s40, s28
  s_mov_b32 s41, s29
  s_mov_b32 s42, 1409024
  s_mov_b32 s43, 0x20000
  s_mov_b32 s44, s30
  s_mov_b32 s45, s31
  s_mov_b32 s46, 1409024
  s_mov_b32 s47, 0x20000
  v_lshl_add_u32 v14, v1, 2, v2
  v_lshlrev_b32 v14, 1, v14
  buffer_load_dwordx4 v[4:7], v3, s[56:59], 0 offen
  buffer_load_dwordx4 v[8:11], v3, s[56:59], 0 offen offset:1024
  buffer_load_ushort v12, v14, s[56:59], s13 offen
  buffer_load_ushort v13, v14, s[56:59], s13 offen offset:1024
  v_mul_u32_u24 v18, 2752, v2
  v_lshl_add_u32 v18, v1, 3, v18
  s_mul_i32 s8, s5, 176128
  s_and_b32 s7, s4, 1
  s_lshr_b32 s14, s4, 2
  s_bitcmp1_b32 0x49, s14
  s_cselect_b32 s15, 48, 40
  s_mov_b32 s68, 0x03ff03ff
  s_cmov_b32 s68, 0x0fff0fff
  s_mov_b32 s69, s68
  s_mov_b32 s10, 0x100b0600
  s_mov_b32 s11, 0x26201b16
  s_lshl_b32 s14, s14, 3
  s_lshr_b64 s[10:11], s[10:11], s14
  s_and_b32 s10, s10, 0xff
  s_lshl_b32 s10, s10, 5
  s_and_b32 s9, s4, 3
  s_mul_i32 s9, s9, s15
  s_add_u32 s9, s9, s10
  s_lshl_b32 s10, s9, 1
  s_add_u32 s8, s8, s10
  v_lshlrev_b32 v16, 4, v1
  s_mov_b64 exec, s[68:69]
  buffer_load_dwordx2 v[32:33], v18, s[40:43], s8 offen
  buffer_load_dwordx2 v[34:35], v18, s[44:47], s8 offen
  s_add_u32 s8, s8, 11008
  buffer_load_dwordx2 v[36:37], v18, s[40:43], s8 offen
  buffer_load_dwordx2 v[38:39], v18, s[44:47], s8 offen
  s_add_u32 s8, s8, 11008
  buffer_load_dwordx2 v[40:41], v18, s[40:43], s8 offen
  buffer_load_dwordx2 v[42:43], v18, s[44:47], s8 offen
  s_add_u32 s8, s8, 11008
  buffer_load_dwordx2 v[44:45], v18, s[40:43], s8 offen
  buffer_load_dwordx2 v[46:47], v18, s[44:47], s8 offen
  s_add_u32 s8, s8, 11008
  buffer_load_dwordx2 v[48:49], v18, s[40:43], s8 offen
  buffer_load_dwordx2 v[50:51], v18, s[44:47], s8 offen
  s_add_u32 s8, s8, 11008
  buffer_load_dwordx2 v[52:53], v18, s[40:43], s8 offen
  buffer_load_dwordx2 v[54:55], v18, s[44:47], s8 offen
  s_add_u32 s8, s8, 11008
  buffer_load_dwordx2 v[56:57], v18, s[40:43], s8 offen
  buffer_load_dwordx2 v[58:59], v18, s[44:47], s8 offen
  s_add_u32 s8, s8, 11008
  buffer_load_dwordx2 v[60:61], v18, s[40:43], s8 offen
  buffer_load_dwordx2 v[62:63], v18, s[44:47], s8 offen
  s_add_u32 s8, s8, 11008
  buffer_load_dwordx2 v[64:65], v18, s[40:43], s8 offen
  buffer_load_dwordx2 v[66:67], v18, s[44:47], s8 offen
  s_add_u32 s8, s8, 11008
  buffer_load_dwordx2 v[68:69], v18, s[40:43], s8 offen
  buffer_load_dwordx2 v[70:71], v18, s[44:47], s8 offen
  s_add_u32 s8, s8, 11008
  buffer_load_dwordx2 v[72:73], v18, s[40:43], s8 offen
  buffer_load_dwordx2 v[74:75], v18, s[44:47], s8 offen
  s_add_u32 s8, s8, 11008
  buffer_load_dwordx2 v[76:77], v18, s[40:43], s8 offen
  buffer_load_dwordx2 v[78:79], v18, s[44:47], s8 offen
  s_add_u32 s8, s8, 11008
  buffer_load_dwordx2 v[80:81], v18, s[40:43], s8 offen
  buffer_load_dwordx2 v[82:83], v18, s[44:47], s8 offen
  s_add_u32 s8, s8, 11008
  buffer_load_dwordx2 v[84:85], v18, s[40:43], s8 offen
  buffer_load_dwordx2 v[86:87], v18, s[44:47], s8 offen
  s_add_u32 s8, s8, 11008
  buffer_load_dwordx2 v[88:89], v18, s[40:43], s8 offen
  buffer_load_dwordx2 v[90:91], v18, s[44:47], s8 offen
  s_add_u32 s8, s8, 11008
  buffer_load_dwordx2 v[92:93], v18, s[40:43], s8 offen
  buffer_load_dwordx2 v[94:95], v18, s[44:47], s8 offen
  s_mov_b64 exec, -1
  s_mov_b32 s48, s38
  s_mov_b32 s49, s39
  s_mov_b32 s50, 2097152
  s_mov_b32 s51, 0x20000
  v_lshrrev_b32 v15, 1, v2
  v_lshlrev_b32 v15, 8, v15
  v_lshl_add_u32 v15, v1, 4, v15
  v_and_b32 v16, 1, v2
  v_lshl_add_u32 v15, v16, 3, v15
  s_waitcnt vmcnt(32)
  v_lshlrev_b32 v112, 16, v4
  v_and_b32 v113, s12, v4
  v_lshlrev_b32 v114, 16, v5
  v_and_b32 v115, s12, v5
  v_lshlrev_b32 v116, 16, v6
  v_and_b32 v117, s12, v6
  v_lshlrev_b32 v118, 16, v7
  v_and_b32 v119, s12, v7
  v_lshlrev_b32 v120, 16, v8
  v_and_b32 v121, s12, v8
  v_lshlrev_b32 v122, 16, v9
  v_and_b32 v123, s12, v9
  v_lshlrev_b32 v124, 16, v10
  v_and_b32 v125, s12, v10
  v_lshlrev_b32 v126, 16, v11
  v_and_b32 v127, s12, v11
  v_add_f32 v128, v112, v113
  v_add_f32 v129, v120, v121
  v_add_f32 v130, v114, v115
  v_add_f32 v131, v122, v123
  v_add_f32 v128, v128, v116
  v_add_f32 v129, v129, v124
  v_add_f32 v130, v130, v117
  v_add_f32 v131, v131, v125
  v_add_f32 v128, v128, v118
  v_add_f32 v129, v129, v126
  v_add_f32 v130, v130, v119
  v_add_f32 v131, v131, v127
  v_add_f32 v128, v128, v130
  v_add_f32 v129, v129, v131
  s_nop 0
  v_add_f32_dpp v128, v128, v128 row_ror:8 row_mask:0xf bank_mask:0xf
  v_add_f32_dpp v129, v129, v129 row_ror:8 row_mask:0xf bank_mask:0xf
  s_nop 0
  v_add_f32_dpp v128, v128, v128 row_ror:4 row_mask:0xf bank_mask:0xf
  v_add_f32_dpp v129, v129, v129 row_ror:4 row_mask:0xf bank_mask:0xf
  s_nop 0
  v_add_f32_dpp v128, v128, v128 row_ror:2 row_mask:0xf bank_mask:0xf
  v_add_f32_dpp v129, v129, v129 row_ror:2 row_mask:0xf bank_mask:0xf
  s_nop 0
  v_add_f32_dpp v128, v128, v128 row_ror:1 row_mask:0xf bank_mask:0xf
  v_add_f32_dpp v129, v129, v129 row_ror:1 row_mask:0xf bank_mask:0xf
  v_mov_b32 v130, v128
  v_mov_b32 v131, v129
  s_nop 0
  v_permlane16_swap_b32 v128, v130
  v_permlane16_swap_b32 v129, v131
  v_add_f32 v128, v128, v130
  v_add_f32 v129, v129, v131
  v_mov_b32 v130, v128
  v_mov_b32 v131, v129
  s_nop 0
  v_permlane32_swap_b32 v128, v130
  v_permlane32_swap_b32 v129, v131
  v_add_f32 v128, v128, v130
  v_add_f32 v129, v129, v131
  v_mul_f32 v132, 0x3b000000, v128
  v_mul_f32 v133, 0x3b000000, v129
  v_sub_f32 v134, v112, v132
  v_sub_f32 v135, v120, v133
  v_mul_f32 v128, v134, v134
  v_mul_f32 v129, v135, v135
  v_sub_f32 v134, v113, v132
  v_sub_f32 v135, v121, v133
  v_fmac_f32 v128, v134, v134
  v_fmac_f32 v129, v135, v135
  v_sub_f32 v134, v114, v132
  v_sub_f32 v135, v122, v133
  v_fmac_f32 v128, v134, v134
  v_fmac_f32 v129, v135, v135
  v_sub_f32 v134, v115, v132
  v_sub_f32 v135, v123, v133
  v_fmac_f32 v128, v134, v134
  v_fmac_f32 v129, v135, v135
  v_sub_f32 v134, v116, v132
  v_sub_f32 v135, v124, v133
  v_fmac_f32 v128, v134, v134
  v_fmac_f32 v129, v135, v135
  v_sub_f32 v134, v117, v132
  v_sub_f32 v135, v125, v133
  v_fmac_f32 v128, v134, v134
  v_fmac_f32 v129, v135, v135
  v_sub_f32 v134, v118, v132
  v_sub_f32 v135, v126, v133
  v_fmac_f32 v128, v134, v134
  v_fmac_f32 v129, v135, v135
  v_sub_f32 v134, v119, v132
  v_sub_f32 v135, v127, v133
  v_fmac_f32 v128, v134, v134
  v_fmac_f32 v129, v135, v135
  s_nop 0
  v_add_f32_dpp v128, v128, v128 row_ror:8 row_mask:0xf bank_mask:0xf
  v_add_f32_dpp v129, v129, v129 row_ror:8 row_mask:0xf bank_mask:0xf
  s_nop 0
  v_add_f32_dpp v128, v128, v128 row_ror:4 row_mask:0xf bank_mask:0xf
  v_add_f32_dpp v129, v129, v129 row_ror:4 row_mask:0xf bank_mask:0xf
  s_nop 0
  v_add_f32_dpp v128, v128, v128 row_ror:2 row_mask:0xf bank_mask:0xf
  v_add_f32_dpp v129, v129, v129 row_ror:2 row_mask:0xf bank_mask:0xf
  s_nop 0
  v_add_f32_dpp v128, v128, v128 row_ror:1 row_mask:0xf bank_mask:0xf
  v_add_f32_dpp v129, v129, v129 row_ror:1 row_mask:0xf bank_mask:0xf
  v_mov_b32 v130, v128
  v_mov_b32 v131, v129
  s_nop 0
  v_permlane16_swap_b32 v128, v130
  v_permlane16_swap_b32 v129, v131
  v_add_f32 v128, v128, v130
  v_add_f32 v129, v129, v131
  v_mov_b32 v130, v128
  v_mov_b32 v131, v129
  s_nop 0
  v_permlane32_swap_b32 v128, v130
  v_permlane32_swap_b32 v129, v131
  v_add_f32 v128, v128, v130
  v_add_f32 v129, v129, v131
  v_mul_f32 v128, 0x3b000000, v128
  v_mul_f32 v129, 0x3b000000, v129
  v_cvt_pk_bf16_f32 v130, v128, v132
  v_lshlrev_b32 v128, 16, v130
  v_and_b32 v132, s12, v130
  v_cvt_pk_bf16_f32 v131, v129, v133
  v_lshlrev_b32 v129, 16, v131
  v_and_b32 v133, s12, v131
  v_add_f32 v128, 0x3727c5ac, v128
  v_add_f32 v129, 0x3727c5ac, v129
  v_cvt_pk_bf16_f32 v130, v128, v129
  v_lshlrev_b32 v128, 16, v130
  v_and_b32 v129, s12, v130
  v_sqrt_f32 v128, v128
  v_sqrt_f32 v129, v129
  s_nop 0
  v_cvt_pk_bf16_f32 v130, v128, v129
  v_lshlrev_b32 v128, 16, v130
  v_and_b32 v129, s12, v130
  v_rcp_f32 v134, v128
  v_rcp_f32 v135, v129
  v_lshlrev_b32 v12, 16, v12
  v_lshlrev_b32 v13, 16, v13
  v_sub_f32 v12, v12, v132
  v_sub_f32 v13, v13, v133
  v_cvt_pk_bf16_f32 v130, v12, v13
  v_lshlrev_b32 v12, 16, v130
  v_and_b32 v13, s12, v130
  v_mul_f32 v12, v12, v134
  v_mul_f32 v13, v13, v135
  v_cvt_pk_bf16_f32 v112, v12, v13
  v_lshlrev_b32 v12, 16, v112
  v_and_b32 v13, s12, v112
  s_waitcnt lgkmcnt(0)
  s_add_u32 s63, s63, 0x01010108
  s_andn2_b32 s54, s63, 7
  s_or_b32 s63, s54, s55
  s_and_b32 s61, s63, 0xff
  s_and_b32 s53, s54, 0xff
  s_bfe_u32 s26, s54, 0x80008
  s_bfe_u32 s27, s54, 0x80010
  s_lshr_b32 s36, s54, 24
  s_mov_b32 s60, 0xffffff00
  v_mov_b32 v31, s61
  v_mov_b32 v30, s53
  v_mov_b32 v29, s26
  v_mov_b32 v28, s27
  v_mov_b32 v27, s36
  s_waitcnt vmcnt(30)
  v_lshlrev_b32 v112, 16, v32
  v_and_b32 v113, s12, v32
  v_lshlrev_b32 v114, 16, v33
  v_and_b32 v115, s12, v33
  v_lshlrev_b32 v116, 16, v34
  v_and_b32 v117, s12, v34
  v_lshlrev_b32 v118, 16, v35
  v_and_b32 v119, s12, v35
  v_mul_f32_dpp v96, v12, v112 row_newbcast:0 row_mask:0xf bank_mask:0xf
  v_mul_f32_dpp v97, v12, v113 row_newbcast:0 row_mask:0xf bank_mask:0xf
  v_mul_f32_dpp v98, v12, v114 row_newbcast:0 row_mask:0xf bank_mask:0xf
  v_mul_f32_dpp v99, v12, v115 row_newbcast:0 row_mask:0xf bank_mask:0xf
  v_mul_f32_dpp v100, v12, v116 row_newbcast:0 row_mask:0xf bank_mask:0xf
  v_mul_f32_dpp v101, v12, v117 row_newbcast:0 row_mask:0xf bank_mask:0xf
  v_mul_f32_dpp v102, v12, v118 row_newbcast:0 row_mask:0xf bank_mask:0xf
  v_mul_f32_dpp v103, v12, v119 row_newbcast:0 row_mask:0xf bank_mask:0xf
  v_mul_f32_dpp v104, v13, v112 row_newbcast:0 row_mask:0xf bank_mask:0xf
  v_mul_f32_dpp v105, v13, v113 row_newbcast:0 row_mask:0xf bank_mask:0xf
  v_mul_f32_dpp v106, v13, v114 row_newbcast:0 row_mask:0xf bank_mask:0xf
  v_mul_f32_dpp v107, v13, v115 row_newbcast:0 row_mask:0xf bank_mask:0xf
  v_mul_f32_dpp v108, v13, v116 row_newbcast:0 row_mask:0xf bank_mask:0xf
  v_mul_f32_dpp v109, v13, v117 row_newbcast:0 row_mask:0xf bank_mask:0xf
  v_mul_f32_dpp v110, v13, v118 row_newbcast:0 row_mask:0xf bank_mask:0xf
  v_mul_f32_dpp v111, v13, v119 row_newbcast:0 row_mask:0xf bank_mask:0xf
  s_waitcnt vmcnt(28)
  v_lshlrev_b32 v120, 16, v36
  v_and_b32 v121, s12, v36
  v_lshlrev_b32 v122, 16, v37
  v_and_b32 v123, s12, v37
  v_lshlrev_b32 v124, 16, v38
  v_and_b32 v125, s12, v38
  v_lshlrev_b32 v126, 16, v39
  v_and_b32 v127, s12, v39
  v_fmac_f32_dpp v96, v12, v120 row_newbcast:1 row_mask:0xf bank_mask:0xf
  v_fmac_f32_dpp v97, v12, v121 row_newbcast:1 row_mask:0xf bank_mask:0xf
  v_fmac_f32_dpp v98, v12, v122 row_newbcast:1 row_mask:0xf bank_mask:0xf
  v_fmac_f32_dpp v99, v12, v123 row_newbcast:1 row_mask:0xf bank_mask:0xf
  v_fmac_f32_dpp v100, v12, v124 row_newbcast:1 row_mask:0xf bank_mask:0xf
  v_fmac_f32_dpp v101, v12, v125 row_newbcast:1 row_mask:0xf bank_mask:0xf
  v_fmac_f32_dpp v102, v12, v126 row_newbcast:1 row_mask:0xf bank_mask:0xf
  v_fmac_f32_dpp v103, v12, v127 row_newbcast:1 row_mask:0xf bank_mask:0xf
  v_fmac_f32_dpp v104, v13, v120 row_newbcast:1 row_mask:0xf bank_mask:0xf
  v_fmac_f32_dpp v105, v13, v121 row_newbcast:1 row_mask:0xf bank_mask:0xf
  v_fmac_f32_dpp v106, v13, v122 row_newbcast:1 row_mask:0xf bank_mask:0xf
  v_fmac_f32_dpp v107, v13, v123 row_newbcast:1 row_mask:0xf bank_mask:0xf
  v_fmac_f32_dpp v108, v13, v124 row_newbcast:1 row_mask:0xf bank_mask:0xf
  v_fmac_f32_dpp v109, v13, v125 row_newbcast:1 row_mask:0xf bank_mask:0xf
  v_fmac_f32_dpp v110, v13, v126 row_newbcast:1 row_mask:0xf bank_mask:0xf
  v_fmac_f32_dpp v111, v13, v127 row_newbcast:1 row_mask:0xf bank_mask:0xf
  s_waitcnt vmcnt(26)
  v_lshlrev_b32 v112, 16, v40
  v_and_b32 v113, s12, v40
  v_lshlrev_b32 v114, 16, v41
  v_and_b32 v115, s12, v41
  v_lshlrev_b32 v116, 16, v42
  v_and_b32 v117, s12, v42
  v_lshlrev_b32 v118, 16, v43
  v_and_b32 v119, s12, v43
  v_fmac_f32_dpp v96, v12, v112 row_newbcast:2 row_mask:0xf bank_mask:0xf
  v_fmac_f32_dpp v97, v12, v113 row_newbcast:2 row_mask:0xf bank_mask:0xf
  v_fmac_f32_dpp v98, v12, v114 row_newbcast:2 row_mask:0xf bank_mask:0xf
  v_fmac_f32_dpp v99, v12, v115 row_newbcast:2 row_mask:0xf bank_mask:0xf
  v_fmac_f32_dpp v100, v12, v116 row_newbcast:2 row_mask:0xf bank_mask:0xf
  v_fmac_f32_dpp v101, v12, v117 row_newbcast:2 row_mask:0xf bank_mask:0xf
  v_fmac_f32_dpp v102, v12, v118 row_newbcast:2 row_mask:0xf bank_mask:0xf
  v_fmac_f32_dpp v103, v12, v119 row_newbcast:2 row_mask:0xf bank_mask:0xf
  v_fmac_f32_dpp v104, v13, v112 row_newbcast:2 row_mask:0xf bank_mask:0xf
  v_fmac_f32_dpp v105, v13, v113 row_newbcast:2 row_mask:0xf bank_mask:0xf
  v_fmac_f32_dpp v106, v13, v114 row_newbcast:2 row_mask:0xf bank_mask:0xf
  v_fmac_f32_dpp v107, v13, v115 row_newbcast:2 row_mask:0xf bank_mask:0xf
  v_fmac_f32_dpp v108, v13, v116 row_newbcast:2 row_mask:0xf bank_mask:0xf
  v_fmac_f32_dpp v109, v13, v117 row_newbcast:2 row_mask:0xf bank_mask:0xf
  v_fmac_f32_dpp v110, v13, v118 row_newbcast:2 row_mask:0xf bank_mask:0xf
  v_fmac_f32_dpp v111, v13, v119 row_newbcast:2 row_mask:0xf bank_mask:0xf
  s_waitcnt vmcnt(24)
  v_lshlrev_b32 v120, 16, v44
  v_and_b32 v121, s12, v44
  v_lshlrev_b32 v122, 16, v45
  v_and_b32 v123, s12, v45
  v_lshlrev_b32 v124, 16, v46
  v_and_b32 v125, s12, v46
  v_lshlrev_b32 v126, 16, v47
  v_and_b32 v127, s12, v47
  v_fmac_f32_dpp v96, v12, v120 row_newbcast:3 row_mask:0xf bank_mask:0xf
  v_fmac_f32_dpp v97, v12, v121 row_newbcast:3 row_mask:0xf bank_mask:0xf
  v_fmac_f32_dpp v98, v12, v122 row_newbcast:3 row_mask:0xf bank_mask:0xf
  v_fmac_f32_dpp v99, v12, v123 row_newbcast:3 row_mask:0xf bank_mask:0xf
  v_fmac_f32_dpp v100, v12, v124 row_newbcast:3 row_mask:0xf bank_mask:0xf
  v_fmac_f32_dpp v101, v12, v125 row_newbcast:3 row_mask:0xf bank_mask:0xf
  v_fmac_f32_dpp v102, v12, v126 row_newbcast:3 row_mask:0xf bank_mask:0xf
  v_fmac_f32_dpp v103, v12, v127 row_newbcast:3 row_mask:0xf bank_mask:0xf
  v_fmac_f32_dpp v104, v13, v120 row_newbcast:3 row_mask:0xf bank_mask:0xf
  v_fmac_f32_dpp v105, v13, v121 row_newbcast:3 row_mask:0xf bank_mask:0xf
  v_fmac_f32_dpp v106, v13, v122 row_newbcast:3 row_mask:0xf bank_mask:0xf
  v_fmac_f32_dpp v107, v13, v123 row_newbcast:3 row_mask:0xf bank_mask:0xf
  v_fmac_f32_dpp v108, v13, v124 row_newbcast:3 row_mask:0xf bank_mask:0xf
  v_fmac_f32_dpp v109, v13, v125 row_newbcast:3 row_mask:0xf bank_mask:0xf
  v_fmac_f32_dpp v110, v13, v126 row_newbcast:3 row_mask:0xf bank_mask:0xf
  v_fmac_f32_dpp v111, v13, v127 row_newbcast:3 row_mask:0xf bank_mask:0xf
  s_waitcnt vmcnt(22)
  v_lshlrev_b32 v112, 16, v48
  v_and_b32 v113, s12, v48
  v_lshlrev_b32 v114, 16, v49
  v_and_b32 v115, s12, v49
  v_lshlrev_b32 v116, 16, v50
  v_and_b32 v117, s12, v50
  v_lshlrev_b32 v118, 16, v51
  v_and_b32 v119, s12, v51
  v_fmac_f32_dpp v96, v12, v112 row_newbcast:4 row_mask:0xf bank_mask:0xf
  v_fmac_f32_dpp v97, v12, v113 row_newbcast:4 row_mask:0xf bank_mask:0xf
  v_fmac_f32_dpp v98, v12, v114 row_newbcast:4 row_mask:0xf bank_mask:0xf
  v_fmac_f32_dpp v99, v12, v115 row_newbcast:4 row_mask:0xf bank_mask:0xf
  v_fmac_f32_dpp v100, v12, v116 row_newbcast:4 row_mask:0xf bank_mask:0xf
  v_fmac_f32_dpp v101, v12, v117 row_newbcast:4 row_mask:0xf bank_mask:0xf
  v_fmac_f32_dpp v102, v12, v118 row_newbcast:4 row_mask:0xf bank_mask:0xf
  v_fmac_f32_dpp v103, v12, v119 row_newbcast:4 row_mask:0xf bank_mask:0xf
  v_fmac_f32_dpp v104, v13, v112 row_newbcast:4 row_mask:0xf bank_mask:0xf
  v_fmac_f32_dpp v105, v13, v113 row_newbcast:4 row_mask:0xf bank_mask:0xf
  v_fmac_f32_dpp v106, v13, v114 row_newbcast:4 row_mask:0xf bank_mask:0xf
  v_fmac_f32_dpp v107, v13, v115 row_newbcast:4 row_mask:0xf bank_mask:0xf
  v_fmac_f32_dpp v108, v13, v116 row_newbcast:4 row_mask:0xf bank_mask:0xf
  v_fmac_f32_dpp v109, v13, v117 row_newbcast:4 row_mask:0xf bank_mask:0xf
  v_fmac_f32_dpp v110, v13, v118 row_newbcast:4 row_mask:0xf bank_mask:0xf
  v_fmac_f32_dpp v111, v13, v119 row_newbcast:4 row_mask:0xf bank_mask:0xf
  s_waitcnt vmcnt(20)
  v_lshlrev_b32 v120, 16, v52
  v_and_b32 v121, s12, v52
  v_lshlrev_b32 v122, 16, v53
  v_and_b32 v123, s12, v53
  v_lshlrev_b32 v124, 16, v54
  v_and_b32 v125, s12, v54
  v_lshlrev_b32 v126, 16, v55
  v_and_b32 v127, s12, v55
  v_fmac_f32_dpp v96, v12, v120 row_newbcast:5 row_mask:0xf bank_mask:0xf
  v_fmac_f32_dpp v97, v12, v121 row_newbcast:5 row_mask:0xf bank_mask:0xf
  v_fmac_f32_dpp v98, v12, v122 row_newbcast:5 row_mask:0xf bank_mask:0xf
  v_fmac_f32_dpp v99, v12, v123 row_newbcast:5 row_mask:0xf bank_mask:0xf
  v_fmac_f32_dpp v100, v12, v124 row_newbcast:5 row_mask:0xf bank_mask:0xf
  v_fmac_f32_dpp v101, v12, v125 row_newbcast:5 row_mask:0xf bank_mask:0xf
  v_fmac_f32_dpp v102, v12, v126 row_newbcast:5 row_mask:0xf bank_mask:0xf
  v_fmac_f32_dpp v103, v12, v127 row_newbcast:5 row_mask:0xf bank_mask:0xf
  v_fmac_f32_dpp v104, v13, v120 row_newbcast:5 row_mask:0xf bank_mask:0xf
  v_fmac_f32_dpp v105, v13, v121 row_newbcast:5 row_mask:0xf bank_mask:0xf
  v_fmac_f32_dpp v106, v13, v122 row_newbcast:5 row_mask:0xf bank_mask:0xf
  v_fmac_f32_dpp v107, v13, v123 row_newbcast:5 row_mask:0xf bank_mask:0xf
  v_fmac_f32_dpp v108, v13, v124 row_newbcast:5 row_mask:0xf bank_mask:0xf
  v_fmac_f32_dpp v109, v13, v125 row_newbcast:5 row_mask:0xf bank_mask:0xf
  v_fmac_f32_dpp v110, v13, v126 row_newbcast:5 row_mask:0xf bank_mask:0xf
  v_fmac_f32_dpp v111, v13, v127 row_newbcast:5 row_mask:0xf bank_mask:0xf
  s_waitcnt vmcnt(18)
  v_lshlrev_b32 v112, 16, v56
  v_and_b32 v113, s12, v56
  v_lshlrev_b32 v114, 16, v57
  v_and_b32 v115, s12, v57
  v_lshlrev_b32 v116, 16, v58
  v_and_b32 v117, s12, v58
  v_lshlrev_b32 v118, 16, v59
  v_and_b32 v119, s12, v59
  v_fmac_f32_dpp v96, v12, v112 row_newbcast:6 row_mask:0xf bank_mask:0xf
  v_fmac_f32_dpp v97, v12, v113 row_newbcast:6 row_mask:0xf bank_mask:0xf
  v_fmac_f32_dpp v98, v12, v114 row_newbcast:6 row_mask:0xf bank_mask:0xf
  v_fmac_f32_dpp v99, v12, v115 row_newbcast:6 row_mask:0xf bank_mask:0xf
  v_fmac_f32_dpp v100, v12, v116 row_newbcast:6 row_mask:0xf bank_mask:0xf
  v_fmac_f32_dpp v101, v12, v117 row_newbcast:6 row_mask:0xf bank_mask:0xf
  v_fmac_f32_dpp v102, v12, v118 row_newbcast:6 row_mask:0xf bank_mask:0xf
  v_fmac_f32_dpp v103, v12, v119 row_newbcast:6 row_mask:0xf bank_mask:0xf
  v_fmac_f32_dpp v104, v13, v112 row_newbcast:6 row_mask:0xf bank_mask:0xf
  v_fmac_f32_dpp v105, v13, v113 row_newbcast:6 row_mask:0xf bank_mask:0xf
  v_fmac_f32_dpp v106, v13, v114 row_newbcast:6 row_mask:0xf bank_mask:0xf
  v_fmac_f32_dpp v107, v13, v115 row_newbcast:6 row_mask:0xf bank_mask:0xf
  v_fmac_f32_dpp v108, v13, v116 row_newbcast:6 row_mask:0xf bank_mask:0xf
  v_fmac_f32_dpp v109, v13, v117 row_newbcast:6 row_mask:0xf bank_mask:0xf
  v_fmac_f32_dpp v110, v13, v118 row_newbcast:6 row_mask:0xf bank_mask:0xf
  v_fmac_f32_dpp v111, v13, v119 row_newbcast:6 row_mask:0xf bank_mask:0xf
  s_waitcnt vmcnt(16)
  v_lshlrev_b32 v120, 16, v60
  v_and_b32 v121, s12, v60
  v_lshlrev_b32 v122, 16, v61
  v_and_b32 v123, s12, v61
  v_lshlrev_b32 v124, 16, v62
  v_and_b32 v125, s12, v62
  v_lshlrev_b32 v126, 16, v63
  v_and_b32 v127, s12, v63
  v_fmac_f32_dpp v96, v12, v120 row_newbcast:7 row_mask:0xf bank_mask:0xf
  v_fmac_f32_dpp v97, v12, v121 row_newbcast:7 row_mask:0xf bank_mask:0xf
  v_fmac_f32_dpp v98, v12, v122 row_newbcast:7 row_mask:0xf bank_mask:0xf
  v_fmac_f32_dpp v99, v12, v123 row_newbcast:7 row_mask:0xf bank_mask:0xf
  v_fmac_f32_dpp v100, v12, v124 row_newbcast:7 row_mask:0xf bank_mask:0xf
  v_fmac_f32_dpp v101, v12, v125 row_newbcast:7 row_mask:0xf bank_mask:0xf
  v_fmac_f32_dpp v102, v12, v126 row_newbcast:7 row_mask:0xf bank_mask:0xf
  v_fmac_f32_dpp v103, v12, v127 row_newbcast:7 row_mask:0xf bank_mask:0xf
  v_fmac_f32_dpp v104, v13, v120 row_newbcast:7 row_mask:0xf bank_mask:0xf
  v_fmac_f32_dpp v105, v13, v121 row_newbcast:7 row_mask:0xf bank_mask:0xf
  v_fmac_f32_dpp v106, v13, v122 row_newbcast:7 row_mask:0xf bank_mask:0xf
  v_fmac_f32_dpp v107, v13, v123 row_newbcast:7 row_mask:0xf bank_mask:0xf
  v_fmac_f32_dpp v108, v13, v124 row_newbcast:7 row_mask:0xf bank_mask:0xf
  v_fmac_f32_dpp v109, v13, v125 row_newbcast:7 row_mask:0xf bank_mask:0xf
  v_fmac_f32_dpp v110, v13, v126 row_newbcast:7 row_mask:0xf bank_mask:0xf
  v_fmac_f32_dpp v111, v13, v127 row_newbcast:7 row_mask:0xf bank_mask:0xf
  s_waitcnt vmcnt(14)
  v_lshlrev_b32 v112, 16, v64
  v_and_b32 v113, s12, v64
  v_lshlrev_b32 v114, 16, v65
  v_and_b32 v115, s12, v65
  v_lshlrev_b32 v116, 16, v66
  v_and_b32 v117, s12, v66
  v_lshlrev_b32 v118, 16, v67
  v_and_b32 v119, s12, v67
  v_fmac_f32_dpp v96, v12, v112 row_newbcast:8 row_mask:0xf bank_mask:0xf
  v_fmac_f32_dpp v97, v12, v113 row_newbcast:8 row_mask:0xf bank_mask:0xf
  v_fmac_f32_dpp v98, v12, v114 row_newbcast:8 row_mask:0xf bank_mask:0xf
  v_fmac_f32_dpp v99, v12, v115 row_newbcast:8 row_mask:0xf bank_mask:0xf
  v_fmac_f32_dpp v100, v12, v116 row_newbcast:8 row_mask:0xf bank_mask:0xf
  v_fmac_f32_dpp v101, v12, v117 row_newbcast:8 row_mask:0xf bank_mask:0xf
  v_fmac_f32_dpp v102, v12, v118 row_newbcast:8 row_mask:0xf bank_mask:0xf
  v_fmac_f32_dpp v103, v12, v119 row_newbcast:8 row_mask:0xf bank_mask:0xf
  v_fmac_f32_dpp v104, v13, v112 row_newbcast:8 row_mask:0xf bank_mask:0xf
  v_fmac_f32_dpp v105, v13, v113 row_newbcast:8 row_mask:0xf bank_mask:0xf
  v_fmac_f32_dpp v106, v13, v114 row_newbcast:8 row_mask:0xf bank_mask:0xf
  v_fmac_f32_dpp v107, v13, v115 row_newbcast:8 row_mask:0xf bank_mask:0xf
  v_fmac_f32_dpp v108, v13, v116 row_newbcast:8 row_mask:0xf bank_mask:0xf
  v_fmac_f32_dpp v109, v13, v117 row_newbcast:8 row_mask:0xf bank_mask:0xf
  v_fmac_f32_dpp v110, v13, v118 row_newbcast:8 row_mask:0xf bank_mask:0xf
  v_fmac_f32_dpp v111, v13, v119 row_newbcast:8 row_mask:0xf bank_mask:0xf
  s_waitcnt vmcnt(12)
  v_lshlrev_b32 v120, 16, v68
  v_and_b32 v121, s12, v68
  v_lshlrev_b32 v122, 16, v69
  v_and_b32 v123, s12, v69
  v_lshlrev_b32 v124, 16, v70
  v_and_b32 v125, s12, v70
  v_lshlrev_b32 v126, 16, v71
  v_and_b32 v127, s12, v71
  v_fmac_f32_dpp v96, v12, v120 row_newbcast:9 row_mask:0xf bank_mask:0xf
  v_fmac_f32_dpp v97, v12, v121 row_newbcast:9 row_mask:0xf bank_mask:0xf
  v_fmac_f32_dpp v98, v12, v122 row_newbcast:9 row_mask:0xf bank_mask:0xf
  v_fmac_f32_dpp v99, v12, v123 row_newbcast:9 row_mask:0xf bank_mask:0xf
  v_fmac_f32_dpp v100, v12, v124 row_newbcast:9 row_mask:0xf bank_mask:0xf
  v_fmac_f32_dpp v101, v12, v125 row_newbcast:9 row_mask:0xf bank_mask:0xf
  v_fmac_f32_dpp v102, v12, v126 row_newbcast:9 row_mask:0xf bank_mask:0xf
  v_fmac_f32_dpp v103, v12, v127 row_newbcast:9 row_mask:0xf bank_mask:0xf
  v_fmac_f32_dpp v104, v13, v120 row_newbcast:9 row_mask:0xf bank_mask:0xf
  v_fmac_f32_dpp v105, v13, v121 row_newbcast:9 row_mask:0xf bank_mask:0xf
  v_fmac_f32_dpp v106, v13, v122 row_newbcast:9 row_mask:0xf bank_mask:0xf
  v_fmac_f32_dpp v107, v13, v123 row_newbcast:9 row_mask:0xf bank_mask:0xf
  v_fmac_f32_dpp v108, v13, v124 row_newbcast:9 row_mask:0xf bank_mask:0xf
  v_fmac_f32_dpp v109, v13, v125 row_newbcast:9 row_mask:0xf bank_mask:0xf
  v_fmac_f32_dpp v110, v13, v126 row_newbcast:9 row_mask:0xf bank_mask:0xf
  v_fmac_f32_dpp v111, v13, v127 row_newbcast:9 row_mask:0xf bank_mask:0xf
  s_waitcnt vmcnt(10)
  v_lshlrev_b32 v112, 16, v72
  v_and_b32 v113, s12, v72
  v_lshlrev_b32 v114, 16, v73
  v_and_b32 v115, s12, v73
  v_lshlrev_b32 v116, 16, v74
  v_and_b32 v117, s12, v74
  v_lshlrev_b32 v118, 16, v75
  v_and_b32 v119, s12, v75
  v_fmac_f32_dpp v96, v12, v112 row_newbcast:10 row_mask:0xf bank_mask:0xf
  v_fmac_f32_dpp v97, v12, v113 row_newbcast:10 row_mask:0xf bank_mask:0xf
  v_fmac_f32_dpp v98, v12, v114 row_newbcast:10 row_mask:0xf bank_mask:0xf
  v_fmac_f32_dpp v99, v12, v115 row_newbcast:10 row_mask:0xf bank_mask:0xf
  v_fmac_f32_dpp v100, v12, v116 row_newbcast:10 row_mask:0xf bank_mask:0xf
  v_fmac_f32_dpp v101, v12, v117 row_newbcast:10 row_mask:0xf bank_mask:0xf
  v_fmac_f32_dpp v102, v12, v118 row_newbcast:10 row_mask:0xf bank_mask:0xf
  v_fmac_f32_dpp v103, v12, v119 row_newbcast:10 row_mask:0xf bank_mask:0xf
  v_fmac_f32_dpp v104, v13, v112 row_newbcast:10 row_mask:0xf bank_mask:0xf
  v_fmac_f32_dpp v105, v13, v113 row_newbcast:10 row_mask:0xf bank_mask:0xf
  v_fmac_f32_dpp v106, v13, v114 row_newbcast:10 row_mask:0xf bank_mask:0xf
  v_fmac_f32_dpp v107, v13, v115 row_newbcast:10 row_mask:0xf bank_mask:0xf
  v_fmac_f32_dpp v108, v13, v116 row_newbcast:10 row_mask:0xf bank_mask:0xf
  v_fmac_f32_dpp v109, v13, v117 row_newbcast:10 row_mask:0xf bank_mask:0xf
  v_fmac_f32_dpp v110, v13, v118 row_newbcast:10 row_mask:0xf bank_mask:0xf
  v_fmac_f32_dpp v111, v13, v119 row_newbcast:10 row_mask:0xf bank_mask:0xf
  s_waitcnt vmcnt(8)
  v_lshlrev_b32 v120, 16, v76
  v_and_b32 v121, s12, v76
  v_lshlrev_b32 v122, 16, v77
  v_and_b32 v123, s12, v77
  v_lshlrev_b32 v124, 16, v78
  v_and_b32 v125, s12, v78
  v_lshlrev_b32 v126, 16, v79
  v_and_b32 v127, s12, v79
  v_fmac_f32_dpp v96, v12, v120 row_newbcast:11 row_mask:0xf bank_mask:0xf
  v_fmac_f32_dpp v97, v12, v121 row_newbcast:11 row_mask:0xf bank_mask:0xf
  v_fmac_f32_dpp v98, v12, v122 row_newbcast:11 row_mask:0xf bank_mask:0xf
  v_fmac_f32_dpp v99, v12, v123 row_newbcast:11 row_mask:0xf bank_mask:0xf
  v_fmac_f32_dpp v100, v12, v124 row_newbcast:11 row_mask:0xf bank_mask:0xf
  v_fmac_f32_dpp v101, v12, v125 row_newbcast:11 row_mask:0xf bank_mask:0xf
  v_fmac_f32_dpp v102, v12, v126 row_newbcast:11 row_mask:0xf bank_mask:0xf
  v_fmac_f32_dpp v103, v12, v127 row_newbcast:11 row_mask:0xf bank_mask:0xf
  v_fmac_f32_dpp v104, v13, v120 row_newbcast:11 row_mask:0xf bank_mask:0xf
  v_fmac_f32_dpp v105, v13, v121 row_newbcast:11 row_mask:0xf bank_mask:0xf
  v_fmac_f32_dpp v106, v13, v122 row_newbcast:11 row_mask:0xf bank_mask:0xf
  v_fmac_f32_dpp v107, v13, v123 row_newbcast:11 row_mask:0xf bank_mask:0xf
  v_fmac_f32_dpp v108, v13, v124 row_newbcast:11 row_mask:0xf bank_mask:0xf
  v_fmac_f32_dpp v109, v13, v125 row_newbcast:11 row_mask:0xf bank_mask:0xf
  v_fmac_f32_dpp v110, v13, v126 row_newbcast:11 row_mask:0xf bank_mask:0xf
  v_fmac_f32_dpp v111, v13, v127 row_newbcast:11 row_mask:0xf bank_mask:0xf
  s_waitcnt vmcnt(6)
  v_lshlrev_b32 v112, 16, v80
  v_and_b32 v113, s12, v80
  v_lshlrev_b32 v114, 16, v81
  v_and_b32 v115, s12, v81
  v_lshlrev_b32 v116, 16, v82
  v_and_b32 v117, s12, v82
  v_lshlrev_b32 v118, 16, v83
  v_and_b32 v119, s12, v83
  v_fmac_f32_dpp v96, v12, v112 row_newbcast:12 row_mask:0xf bank_mask:0xf
  v_fmac_f32_dpp v97, v12, v113 row_newbcast:12 row_mask:0xf bank_mask:0xf
  v_fmac_f32_dpp v98, v12, v114 row_newbcast:12 row_mask:0xf bank_mask:0xf
  v_fmac_f32_dpp v99, v12, v115 row_newbcast:12 row_mask:0xf bank_mask:0xf
  v_fmac_f32_dpp v100, v12, v116 row_newbcast:12 row_mask:0xf bank_mask:0xf
  v_fmac_f32_dpp v101, v12, v117 row_newbcast:12 row_mask:0xf bank_mask:0xf
  v_fmac_f32_dpp v102, v12, v118 row_newbcast:12 row_mask:0xf bank_mask:0xf
  v_fmac_f32_dpp v103, v12, v119 row_newbcast:12 row_mask:0xf bank_mask:0xf
  v_fmac_f32_dpp v104, v13, v112 row_newbcast:12 row_mask:0xf bank_mask:0xf
  v_fmac_f32_dpp v105, v13, v113 row_newbcast:12 row_mask:0xf bank_mask:0xf
  v_fmac_f32_dpp v106, v13, v114 row_newbcast:12 row_mask:0xf bank_mask:0xf
  v_fmac_f32_dpp v107, v13, v115 row_newbcast:12 row_mask:0xf bank_mask:0xf
  v_fmac_f32_dpp v108, v13, v116 row_newbcast:12 row_mask:0xf bank_mask:0xf
  v_fmac_f32_dpp v109, v13, v117 row_newbcast:12 row_mask:0xf bank_mask:0xf
  v_fmac_f32_dpp v110, v13, v118 row_newbcast:12 row_mask:0xf bank_mask:0xf
  v_fmac_f32_dpp v111, v13, v119 row_newbcast:12 row_mask:0xf bank_mask:0xf
  s_waitcnt vmcnt(4)
  v_lshlrev_b32 v120, 16, v84
  v_and_b32 v121, s12, v84
  v_lshlrev_b32 v122, 16, v85
  v_and_b32 v123, s12, v85
  v_lshlrev_b32 v124, 16, v86
  v_and_b32 v125, s12, v86
  v_lshlrev_b32 v126, 16, v87
  v_and_b32 v127, s12, v87
  v_fmac_f32_dpp v96, v12, v120 row_newbcast:13 row_mask:0xf bank_mask:0xf
  v_fmac_f32_dpp v97, v12, v121 row_newbcast:13 row_mask:0xf bank_mask:0xf
  v_fmac_f32_dpp v98, v12, v122 row_newbcast:13 row_mask:0xf bank_mask:0xf
  v_fmac_f32_dpp v99, v12, v123 row_newbcast:13 row_mask:0xf bank_mask:0xf
  v_fmac_f32_dpp v100, v12, v124 row_newbcast:13 row_mask:0xf bank_mask:0xf
  v_fmac_f32_dpp v101, v12, v125 row_newbcast:13 row_mask:0xf bank_mask:0xf
  v_fmac_f32_dpp v102, v12, v126 row_newbcast:13 row_mask:0xf bank_mask:0xf
  v_fmac_f32_dpp v103, v12, v127 row_newbcast:13 row_mask:0xf bank_mask:0xf
  v_fmac_f32_dpp v104, v13, v120 row_newbcast:13 row_mask:0xf bank_mask:0xf
  v_fmac_f32_dpp v105, v13, v121 row_newbcast:13 row_mask:0xf bank_mask:0xf
  v_fmac_f32_dpp v106, v13, v122 row_newbcast:13 row_mask:0xf bank_mask:0xf
  v_fmac_f32_dpp v107, v13, v123 row_newbcast:13 row_mask:0xf bank_mask:0xf
  v_fmac_f32_dpp v108, v13, v124 row_newbcast:13 row_mask:0xf bank_mask:0xf
  v_fmac_f32_dpp v109, v13, v125 row_newbcast:13 row_mask:0xf bank_mask:0xf
  v_fmac_f32_dpp v110, v13, v126 row_newbcast:13 row_mask:0xf bank_mask:0xf
  v_fmac_f32_dpp v111, v13, v127 row_newbcast:13 row_mask:0xf bank_mask:0xf
  s_waitcnt vmcnt(2)
  v_lshlrev_b32 v112, 16, v88
  v_and_b32 v113, s12, v88
  v_lshlrev_b32 v114, 16, v89
  v_and_b32 v115, s12, v89
  v_lshlrev_b32 v116, 16, v90
  v_and_b32 v117, s12, v90
  v_lshlrev_b32 v118, 16, v91
  v_and_b32 v119, s12, v91
  v_fmac_f32_dpp v96, v12, v112 row_newbcast:14 row_mask:0xf bank_mask:0xf
  v_fmac_f32_dpp v97, v12, v113 row_newbcast:14 row_mask:0xf bank_mask:0xf
  v_fmac_f32_dpp v98, v12, v114 row_newbcast:14 row_mask:0xf bank_mask:0xf
  v_fmac_f32_dpp v99, v12, v115 row_newbcast:14 row_mask:0xf bank_mask:0xf
  v_fmac_f32_dpp v100, v12, v116 row_newbcast:14 row_mask:0xf bank_mask:0xf
  v_fmac_f32_dpp v101, v12, v117 row_newbcast:14 row_mask:0xf bank_mask:0xf
  v_fmac_f32_dpp v102, v12, v118 row_newbcast:14 row_mask:0xf bank_mask:0xf
  v_fmac_f32_dpp v103, v12, v119 row_newbcast:14 row_mask:0xf bank_mask:0xf
  v_fmac_f32_dpp v104, v13, v112 row_newbcast:14 row_mask:0xf bank_mask:0xf
  v_fmac_f32_dpp v105, v13, v113 row_newbcast:14 row_mask:0xf bank_mask:0xf
  v_fmac_f32_dpp v106, v13, v114 row_newbcast:14 row_mask:0xf bank_mask:0xf
  v_fmac_f32_dpp v107, v13, v115 row_newbcast:14 row_mask:0xf bank_mask:0xf
  v_fmac_f32_dpp v108, v13, v116 row_newbcast:14 row_mask:0xf bank_mask:0xf
  v_fmac_f32_dpp v109, v13, v117 row_newbcast:14 row_mask:0xf bank_mask:0xf
  v_fmac_f32_dpp v110, v13, v118 row_newbcast:14 row_mask:0xf bank_mask:0xf
  v_fmac_f32_dpp v111, v13, v119 row_newbcast:14 row_mask:0xf bank_mask:0xf
  s_waitcnt vmcnt(0)
  v_lshlrev_b32 v120, 16, v92
  v_and_b32 v121, s12, v92
  v_lshlrev_b32 v122, 16, v93
  v_and_b32 v123, s12, v93
  v_lshlrev_b32 v124, 16, v94
  v_and_b32 v125, s12, v94
  v_lshlrev_b32 v126, 16, v95
  v_and_b32 v127, s12, v95
  v_fmac_f32_dpp v96, v12, v120 row_newbcast:15 row_mask:0xf bank_mask:0xf
  v_fmac_f32_dpp v97, v12, v121 row_newbcast:15 row_mask:0xf bank_mask:0xf
  v_fmac_f32_dpp v98, v12, v122 row_newbcast:15 row_mask:0xf bank_mask:0xf
  v_fmac_f32_dpp v99, v12, v123 row_newbcast:15 row_mask:0xf bank_mask:0xf
  v_fmac_f32_dpp v100, v12, v124 row_newbcast:15 row_mask:0xf bank_mask:0xf
  v_fmac_f32_dpp v101, v12, v125 row_newbcast:15 row_mask:0xf bank_mask:0xf
  v_fmac_f32_dpp v102, v12, v126 row_newbcast:15 row_mask:0xf bank_mask:0xf
  v_fmac_f32_dpp v103, v12, v127 row_newbcast:15 row_mask:0xf bank_mask:0xf
  v_fmac_f32_dpp v104, v13, v120 row_newbcast:15 row_mask:0xf bank_mask:0xf
  v_fmac_f32_dpp v105, v13, v121 row_newbcast:15 row_mask:0xf bank_mask:0xf
  v_fmac_f32_dpp v106, v13, v122 row_newbcast:15 row_mask:0xf bank_mask:0xf
  v_fmac_f32_dpp v107, v13, v123 row_newbcast:15 row_mask:0xf bank_mask:0xf
  v_fmac_f32_dpp v108, v13, v124 row_newbcast:15 row_mask:0xf bank_mask:0xf
  v_fmac_f32_dpp v109, v13, v125 row_newbcast:15 row_mask:0xf bank_mask:0xf
  v_fmac_f32_dpp v110, v13, v126 row_newbcast:15 row_mask:0xf bank_mask:0xf
  v_fmac_f32_dpp v111, v13, v127 row_newbcast:15 row_mask:0xf bank_mask:0xf
  v_permlane32_swap_b32 v96, v104
  v_permlane32_swap_b32 v97, v105
  v_permlane32_swap_b32 v98, v106
  v_permlane32_swap_b32 v99, v107
  v_permlane32_swap_b32 v100, v108
  v_permlane32_swap_b32 v101, v109
  v_permlane32_swap_b32 v102, v110
  v_permlane32_swap_b32 v103, v111
  v_add_f32 v96, v96, v104
  v_add_f32 v97, v97, v105
  v_add_f32 v98, v98, v106
  v_add_f32 v99, v99, v107
  v_add_f32 v100, v100, v108
  v_add_f32 v101, v101, v109
  v_add_f32 v102, v102, v110
  v_add_f32 v103, v103, v111
  v_permlane16_swap_b32 v96, v100
  v_permlane16_swap_b32 v97, v101
  v_permlane16_swap_b32 v98, v102
  v_permlane16_swap_b32 v99, v103
  v_add_f32 v96, v96, v100
  v_add_f32 v97, v97, v101
  v_add_f32 v98, v98, v102
  v_add_f32 v99, v99, v103
  v_and_or_b32 v96, v96, s60, v31
  v_and_or_b32 v97, v97, s60, v29
  v_and_or_b32 v98, v98, s60, v28
  v_and_or_b32 v99, v99, s60, v27
  s_lshl_b32 s8, s4, 13
  s_lshl_b32 s66, s5, 10
  s_add_u32 s66, s66, s8
  s_add_u32 s66, s66, 262144
  s_mov_b64 exec, s[68:69]
  buffer_store_dwordx4 v[96:99], v3, s[48:51], s66 offen
  s_mov_b64 exec, -1
  s_mov_b32 s40, s32
  s_mov_b32 s41, s33
  s_mov_b32 s42, 1409024
  s_mov_b32 s43, 0x20000
  v_lshlrev_b32 v18, 10, v2
  v_lshl_add_u32 v18, v1, 3, v18
  s_lshl_b32 s65, s9, 10
  s_add_u32 s65, s65, s13
  buffer_load_dwordx2 v[112:113], v18, s[40:43], s65 offen nt
  s_add_u32 s65, s65, 0x1000
  buffer_load_dwordx2 v[114:115], v18, s[40:43], s65 offen nt
  s_add_u32 s65, s65, 0x1000
  buffer_load_dwordx2 v[116:117], v18, s[40:43], s65 offen nt
  s_add_u32 s65, s65, 0x1000
  buffer_load_dwordx2 v[118:119], v18, s[40:43], s65 offen nt
  s_add_u32 s65, s65, 0x1000
  buffer_load_dwordx2 v[120:121], v18, s[40:43], s65 offen nt
  s_add_u32 s65, s65, 0x1000
  buffer_load_dwordx2 v[122:123], v18, s[40:43], s65 offen nt
  s_add_u32 s65, s65, 0x1000
  buffer_load_dwordx2 v[124:125], v18, s[40:43], s65 offen nt
  s_add_u32 s65, s65, 0x1000
  buffer_load_dwordx2 v[126:127], v18, s[40:43], s65 offen nt
  s_add_u32 s65, s65, 0x1000
  buffer_load_dwordx2 v[128:129], v18, s[40:43], s65 offen nt
  s_add_u32 s65, s65, 0x1000
  buffer_load_dwordx2 v[130:131], v18, s[40:43], s65 offen nt
  s_add_u32 s65, s65, 0x1000
  s_cmp_le_u32 s15, 40
  s_cbranch_scc1 L_wd_l
  buffer_load_dwordx2 v[132:133], v18, s[40:43], s65 offen nt
  s_add_u32 s65, s65, 0x1000
  buffer_load_dwordx2 v[134:135], v18, s[40:43], s65 offen nt
L_wd_l:
  s_mov_b32 s44, s34
  s_mov_b32 s45, s35
  s_mov_b32 s46, 2048
  s_mov_b32 s47, 0x20000
  s_lshr_b32 s67, s4, 1
  s_lshr_b32 s10, s67, 3
  s_lshl_b32 s10, s10, 10
  s_and_b32 s11, s67, 7
  s_lshl_b32 s11, s11, 4
  s_add_u32 s10, s10, s11
  s_add_u32 s10, s10, s13
  v_and_b32 v24, 1, v1
  v_lshlrev_b32 v24, 2, v24
  v_add_u32 v24, v24, v2
  v_lshlrev_b32 v24, 1, v24
  v_add_u32 v24, s10, v24
  buffer_load_ushort v25, v24, s[56:59], 0 offen
  s_lshl_b32 s8, s4, 13
  s_add_u32 s8, s8, 262144
  s_add_u32 s10, s8, 0x1000
  v_mov_b32 v32, 0
  v_mov_b32 v33, 0
  v_mov_b32 v34, 0
  v_mov_b32 v35, 0
  v_mov_b32 v36, 0
  v_mov_b32 v37, 0
  v_mov_b32 v38, 0
  v_mov_b32 v39, 0
  v_mov_b32 v40, 0
  v_mov_b32 v41, 0
  v_mov_b32 v42, 0
  v_mov_b32 v43, 0
  v_mov_b32 v44, 0
  v_mov_b32 v45, 0
  v_mov_b32 v46, 0
  v_mov_b32 v47, 0
  v_mov_b32 v48, 0
  v_mov_b32 v49, 0
  v_mov_b32 v50, 0
  v_mov_b32 v51, 0
  v_mov_b32 v52, 0
  v_mov_b32 v53, 0
  v_mov_b32 v54, 0
  v_mov_b32 v55, 0
  v_mov_b32 v56, 0
  v_mov_b32 v57, 0
  v_mov_b32 v58, 0
  v_mov_b32 v59, 0
  v_mov_b32 v60, 0
  v_mov_b32 v61, 0
  v_mov_b32 v62, 0
  v_mov_b32 v63, 0
  s_waitcnt vmcnt(0)
  s_mov_b64 exec, s[68:69]
  s_mov_b32 s52, 0
  s_mov_b32 s14, 0
L_f_poll:
  buffer_load_dwordx4 v[32:35], v3, s[48:51], s8 offen offset:0 sc1
  buffer_load_dwordx4 v[36:39], v3, s[48:51], s8 offen offset:1024 sc1
  buffer_load_dwordx4 v[40:43], v3, s[48:51], s8 offen offset:2048 sc1
  buffer_load_dwordx4 v[44:47], v3, s[48:51], s8 offen offset:3072 sc1
  buffer_load_dwordx4 v[48:51], v3, s[48:51], s10 offen offset:0 sc1
  buffer_load_dwordx4 v[52:55], v3, s[48:51], s10 offen offset:1024 sc1
  buffer_load_dwordx4 v[56:59], v3, s[48:51], s10 offen offset:2048 sc1
  buffer_load_dwordx4 v[60:63], v3, s[48:51], s10 offen offset:3072 sc1
  s_waitcnt vmcnt(0)
  v_xor_b32 v32, s61, v32
  v_xor_b32 v33, s26, v33
  v_xor_b32 v34, s27, v34
  v_xor_b32 v35, s36, v35
  v_xor_b32 v36, s61, v36
  v_xor_b32 v37, s26, v37
  v_xor_b32 v38, s27, v38
  v_xor_b32 v39, s36, v39
  v_xor_b32 v40, s61, v40
  v_xor_b32 v41, s26, v41
  v_xor_b32 v42, s27, v42
  v_xor_b32 v43, s36, v43
  v_xor_b32 v44, s61, v44
  v_xor_b32 v45, s26, v45
  v_xor_b32 v46, s27, v46
  v_xor_b32 v47, s36, v47
  v_xor_b32 v48, s61, v48
  v_xor_b32 v49, s26, v49
  v_xor_b32 v50, s27, v50
  v_xor_b32 v51, s36, v51
  v_xor_b32 v52, s61, v52
  v_xor_b32 v53, s26, v53
  v_xor_b32 v54, s27, v54
  v_xor_b32 v55, s36, v55
  v_xor_b32 v56, s61, v56
  v_xor_b32 v57, s26, v57
  v_xor_b32 v58, s27, v58
  v_xor_b32 v59, s36, v59
  v_xor_b32 v60, s61, v60
  v_xor_b32 v61, s26, v61
  v_xor_b32 v62, s27, v62
  v_xor_b32 v63, s36, v63
  v_or3_b32 v68, v32, v33, v34
  v_or3_b32 v68, v68, v35, v36
  v_or3_b32 v68, v68, v37, v38
  v_or3_b32 v68, v68, v39, v40
  v_or3_b32 v68, v68, v41, v42
  v_or3_b32 v68, v68, v43, v44
  v_or3_b32 v68, v68, v45, v46
  v_or3_b32 v68, v68, v47, v48
  v_or3_b32 v68, v68, v49, v50
  v_or3_b32 v68, v68, v51, v52
  v_or3_b32 v68, v68, v53, v54
  v_or3_b32 v68, v68, v55, v56
  v_or3_b32 v68, v68, v57, v58
  v_or3_b32 v68, v68, v59, v60
  v_or3_b32 v68, v68, v61, v62
  v_or3_b32 v68, v68, v63, v63
  v_and_b32 v68, 0xff, v68
  v_cmp_ne_u32 vcc, 0, v68
  s_cbranch_vccz L_f_go
  s_sleep 16
  s_add_u32 s14, s14, 1
  s_cmp_lt_u32 s14, 24
  s_cbranch_scc1 L_f_poll
  s_branch L_f_slow
L_f_go:
  s_mov_b64 exec, -1
  v_add_f32 v32, v32, v36
  v_add_f32 v33, v33, v37
  v_add_f32 v34, v34, v38
  v_add_f32 v35, v35, v39
  v_add_f32 v32, v32, v40
  v_add_f32 v33, v33, v41
  v_add_f32 v34, v34, v42
  v_add_f32 v35, v35, v43
  v_add_f32 v32, v32, v44
  v_add_f32 v33, v33, v45
  v_add_f32 v34, v34, v46
  v_add_f32 v35, v35, v47
  v_add_f32 v32, v32, v48
  v_add_f32 v33, v33, v49
  v_add_f32 v34, v34, v50
  v_add_f32 v35, v35, v51
  v_add_f32 v32, v32, v52
  v_add_f32 v33, v33, v53
  v_add_f32 v34, v34, v54
  v_add_f32 v35, v35, v55
  v_add_f32 v32, v32, v56
  v_add_f32 v33, v33, v57
  v_add_f32 v34, v34, v58
  v_add_f32 v35, v35, v59
  v_add_f32 v32, v32, v60
  v_add_f32 v33, v33, v61
  v_add_f32 v34, v34, v62
  v_add_f32 v35, v35, v63
  v_cvt_pk_bf16_f32 v40, v32, v33
  v_lshlrev_b32 v32, 16, v40
  v_and_b32 v33, s12, v40
  v_cvt_pk_bf16_f32 v41, v34, v35
  v_lshlrev_b32 v34, 16, v41
  v_and_b32 v35, s12, v41
  v_mov_b32 v36, v32
  v_mov_b32 v37, v33
  v_mov_b32 v38, v34
  v_mov_b32 v39, v35
  v_permlane16_swap_b32 v32, v36
  v_permlane16_swap_b32 v33, v37
  v_permlane16_swap_b32 v34, v38
  v_permlane16_swap_b32 v35, v39
  s_mov_b32 s10, 0xbdd2d3e8
  v_mov_b32 v48, 0xc0135761
  v_mul_f32 v40, v32, v32
  v_mul_f32 v41, v33, v33
  v_mul_f32 v42, v34, v34
  v_mul_f32 v43, v35, v35
  v_fma_f32 v40, v40, s10, v48
  v_fma_f32 v41, v41, s10, v48
  v_fma_f32 v42, v42, s10, v48
  v_fma_f32 v43, v43, s10, v48
  v_mul_f32 v40, v40, v32
  v_mul_f32 v41, v41, v33
  v_mul_f32 v42, v42, v34
  v_mul_f32 v43, v43, v35
  v_exp_f32 v40, v40
  v_exp_f32 v41, v41
  v_exp_f32 v42, v42
  v_exp_f32 v43, v43
  v_add_f32 v40, 1.0, v40
  v_add_f32 v41, 1.0, v41
  v_add_f32 v42, 1.0, v42
  v_add_f32 v43, 1.0, v43
  v_rcp_f32 v40, v40
  v_rcp_f32 v41, v41
  v_rcp_f32 v42, v42
  v_rcp_f32 v43, v43
  v_mul_f32 v32, v32, v40
  v_mul_f32 v33, v33, v41
  v_mul_f32 v34, v34, v42
  v_mul_f32 v35, v35, v43
  v_cvt_pk_bf16_f32 v40, v32, v33
  v_lshlrev_b32 v32, 16, v40
  v_and_b32 v33, s12, v40
  v_cvt_pk_bf16_f32 v41, v34, v35
  v_lshlrev_b32 v34, 16, v41
  v_and_b32 v35, s12, v41
  v_mul_f32 v32, v32, v36
  v_mul_f32 v33, v33, v37
  v_mul_f32 v34, v34, v38
  v_mul_f32 v35, v35, v39
  v_cvt_pk_bf16_f32 v40, v32, v33
  v_lshlrev_b32 v32, 16, v40
  v_and_b32 v33, s12, v40
  v_cvt_pk_bf16_f32 v41, v34, v35
  v_lshlrev_b32 v34, 16, v41
  v_and_b32 v35, s12, v41
  v_lshrrev_b32 v16, 1, v2
  v_lshlrev_b32 v16, 8, v16
  v_lshl_add_u32 v16, v1, 4, v16
  ds_write_b128 v16, v[32:35] offset:4608
  v_lshl_add_u32 v17, v1, 2, v2
  v_lshlrev_b32 v16, 2, v17
  s_waitcnt lgkmcnt(0)
  ds_read_b32 v12, v16 offset:4608
  ds_read_b32 v13, v16 offset:4864
  v_cmp_gt_u32 vcc, s15, v17
  s_waitcnt lgkmcnt(0)
  s_nop 0
  v_cndmask_b32 v12, 0, v12, vcc
  v_cndmask_b32 v13, 0, v13, vcc
  s_mov_b32 s37, s66
  v_lshlrev_b32 v40, 16, v112
  v_and_b32 v41, s12, v112
  v_lshlrev_b32 v42, 16, v113
  v_and_b32 v43, s12, v113
  v_mul_f32_dpp v100, v12, v40 row_newbcast:0 row_mask:0xf bank_mask:0xf
  v_mul_f32_dpp v101, v12, v41 row_newbcast:0 row_mask:0xf bank_mask:0xf
  v_mul_f32_dpp v102, v12, v42 row_newbcast:0 row_mask:0xf bank_mask:0xf
  v_mul_f32_dpp v103, v12, v43 row_newbcast:0 row_mask:0xf bank_mask:0xf
  v_mul_f32_dpp v104, v13, v40 row_newbcast:0 row_mask:0xf bank_mask:0xf
  v_mul_f32_dpp v105, v13, v41 row_newbcast:0 row_mask:0xf bank_mask:0xf
  v_mul_f32_dpp v106, v13, v42 row_newbcast:0 row_mask:0xf bank_mask:0xf
  v_mul_f32_dpp v107, v13, v43 row_newbcast:0 row_mask:0xf bank_mask:0xf
  v_lshlrev_b32 v44, 16, v114
  v_and_b32 v45, s12, v114
  v_lshlrev_b32 v46, 16, v115
  v_and_b32 v47, s12, v115
  v_fmac_f32_dpp v100, v12, v44 row_newbcast:1 row_mask:0xf bank_mask:0xf
  v_fmac_f32_dpp v101, v12, v45 row_newbcast:1 row_mask:0xf bank_mask:0xf
  v_fmac_f32_dpp v102, v12, v46 row_newbcast:1 row_mask:0xf bank_mask:0xf
  v_fmac_f32_dpp v103, v12, v47 row_newbcast:1 row_mask:0xf bank_mask:0xf
  v_fmac_f32_dpp v104, v13, v44 row_newbcast:1 row_mask:0xf bank_mask:0xf
  v_fmac_f32_dpp v105, v13, v45 row_newbcast:1 row_mask:0xf bank_mask:0xf
  v_fmac_f32_dpp v106, v13, v46 row_newbcast:1 row_mask:0xf bank_mask:0xf
  v_fmac_f32_dpp v107, v13, v47 row_newbcast:1 row_mask:0xf bank_mask:0xf
  v_lshlrev_b32 v40, 16, v116
  v_and_b32 v41, s12, v116
  v_lshlrev_b32 v42, 16, v117
  v_and_b32 v43, s12, v117
  v_fmac_f32_dpp v100, v12, v40 row_newbcast:2 row_mask:0xf bank_mask:0xf
  v_fmac_f32_dpp v101, v12, v41 row_newbcast:2 row_mask:0xf bank_mask:0xf
  v_fmac_f32_dpp v102, v12, v42 row_newbcast:2 row_mask:0xf bank_mask:0xf
  v_fmac_f32_dpp v103, v12, v43 row_newbcast:2 row_mask:0xf bank_mask:0xf
  v_fmac_f32_dpp v104, v13, v40 row_newbcast:2 row_mask:0xf bank_mask:0xf
  v_fmac_f32_dpp v105, v13, v41 row_newbcast:2 row_mask:0xf bank_mask:0xf
  v_fmac_f32_dpp v106, v13, v42 row_newbcast:2 row_mask:0xf bank_mask:0xf
  v_fmac_f32_dpp v107, v13, v43 row_newbcast:2 row_mask:0xf bank_mask:0xf
  v_lshlrev_b32 v44, 16, v118
  v_and_b32 v45, s12, v118
  v_lshlrev_b32 v46, 16, v119
  v_and_b32 v47, s12, v119
  v_fmac_f32_dpp v100, v12, v44 row_newbcast:3 row_mask:0xf bank_mask:0xf
  v_fmac_f32_dpp v101, v12, v45 row_newbcast:3 row_mask:0xf bank_mask:0xf
  v_fmac_f32_dpp v102, v12, v46 row_newbcast:3 row_mask:0xf bank_mask:0xf
  v_fmac_f32_dpp v103, v12, v47 row_newbcast:3 row_mask:0xf bank_mask:0xf
  v_fmac_f32_dpp v104, v13, v44 row_newbcast:3 row_mask:0xf bank_mask:0xf
  v_fmac_f32_dpp v105, v13, v45 row_newbcast:3 row_mask:0xf bank_mask:0xf
  v_fmac_f32_dpp v106, v13, v46 row_newbcast:3 row_mask:0xf bank_mask:0xf
  v_fmac_f32_dpp v107, v13, v47 row_newbcast:3 row_mask:0xf bank_mask:0xf
  v_lshlrev_b32 v40, 16, v120
  v_and_b32 v41, s12, v120
  v_lshlrev_b32 v42, 16, v121
  v_and_b32 v43, s12, v121
  v_fmac_f32_dpp v100, v12, v40 row_newbcast:4 row_mask:0xf bank_mask:0xf
  v_fmac_f32_dpp v101, v12, v41 row_newbcast:4 row_mask:0xf bank_mask:0xf
  v_fmac_f32_dpp v102, v12, v42 row_newbcast:4 row_mask:0xf bank_mask:0xf
  v_fmac_f32_dpp v103, v12, v43 row_newbcast:4 row_mask:0xf bank_mask:0xf
  v_fmac_f32_dpp v104, v13, v40 row_newbcast:4 row_mask:0xf bank_mask:0xf
  v_fmac_f32_dpp v105, v13, v41 row_newbcast:4 row_mask:0xf bank_mask:0xf
  v_fmac_f32_dpp v106, v13, v42 row_newbcast:4 row_mask:0xf bank_mask:0xf
  v_fmac_f32_dpp v107, v13, v43 row_newbcast:4 row_mask:0xf bank_mask:0xf
  v_lshlrev_b32 v44, 16, v122
  v_and_b32 v45, s12, v122
  v_lshlrev_b32 v46, 16, v123
  v_and_b32 v47, s12, v123
  v_fmac_f32_dpp v100, v12, v44 row_newbcast:5 row_mask:0xf bank_mask:0xf
  v_fmac_f32_dpp v101, v12, v45 row_newbcast:5 row_mask:0xf bank_mask:0xf
  v_fmac_f32_dpp v102, v12, v46 row_newbcast:5 row_mask:0xf bank_mask:0xf
  v_fmac_f32_dpp v103, v12, v47 row_newbcast:5 row_mask:0xf bank_mask:0xf
  v_fmac_f32_dpp v104, v13, v44 row_newbcast:5 row_mask:0xf bank_mask:0xf
  v_fmac_f32_dpp v105, v13, v45 row_newbcast:5 row_mask:0xf bank_mask:0xf
  v_fmac_f32_dpp v106, v13, v46 row_newbcast:5 row_mask:0xf bank_mask:0xf
  v_fmac_f32_dpp v107, v13, v47 row_newbcast:5 row_mask:0xf bank_mask:0xf
  v_lshlrev_b32 v40, 16, v124
  v_and_b32 v41, s12, v124
  v_lshlrev_b32 v42, 16, v125
  v_and_b32 v43, s12, v125
  v_fmac_f32_dpp v100, v12, v40 row_newbcast:6 row_mask:0xf bank_mask:0xf
  v_fmac_f32_dpp v101, v12, v41 row_newbcast:6 row_mask:0xf bank_mask:0xf
  v_fmac_f32_dpp v102, v12, v42 row_newbcast:6 row_mask:0xf bank_mask:0xf
  v_fmac_f32_dpp v103, v12, v43 row_newbcast:6 row_mask:0xf bank_mask:0xf
  v_fmac_f32_dpp v104, v13, v40 row_newbcast:6 row_mask:0xf bank_mask:0xf
  v_fmac_f32_dpp v105, v13, v41 row_newbcast:6 row_mask:0xf bank_mask:0xf
  v_fmac_f32_dpp v106, v13, v42 row_newbcast:6 row_mask:0xf bank_mask:0xf
  v_fmac_f32_dpp v107, v13, v43 row_newbcast:6 row_mask:0xf bank_mask:0xf
  v_lshlrev_b32 v44, 16, v126
  v_and_b32 v45, s12, v126
  v_lshlrev_b32 v46, 16, v127
  v_and_b32 v47, s12, v127
  v_fmac_f32_dpp v100, v12, v44 row_newbcast:7 row_mask:0xf bank_mask:0xf
  v_fmac_f32_dpp v101, v12, v45 row_newbcast:7 row_mask:0xf bank_mask:0xf
  v_fmac_f32_dpp v102, v12, v46 row_newbcast:7 row_mask:0xf bank_mask:0xf
  v_fmac_f32_dpp v103, v12, v47 row_newbcast:7 row_mask:0xf bank_mask:0xf
  v_fmac_f32_dpp v104, v13, v44 row_newbcast:7 row_mask:0xf bank_mask:0xf
  v_fmac_f32_dpp v105, v13, v45 row_newbcast:7 row_mask:0xf bank_mask:0xf
  v_fmac_f32_dpp v106, v13, v46 row_newbcast:7 row_mask:0xf bank_mask:0xf
  v_fmac_f32_dpp v107, v13, v47 row_newbcast:7 row_mask:0xf bank_mask:0xf
  v_lshlrev_b32 v40, 16, v128
  v_and_b32 v41, s12, v128
  v_lshlrev_b32 v42, 16, v129
  v_and_b32 v43, s12, v129
  v_fmac_f32_dpp v100, v12, v40 row_newbcast:8 row_mask:0xf bank_mask:0xf
  v_fmac_f32_dpp v101, v12, v41 row_newbcast:8 row_mask:0xf bank_mask:0xf
  v_fmac_f32_dpp v102, v12, v42 row_newbcast:8 row_mask:0xf bank_mask:0xf
  v_fmac_f32_dpp v103, v12, v43 row_newbcast:8 row_mask:0xf bank_mask:0xf
  v_fmac_f32_dpp v104, v13, v40 row_newbcast:8 row_mask:0xf bank_mask:0xf
  v_fmac_f32_dpp v105, v13, v41 row_newbcast:8 row_mask:0xf bank_mask:0xf
  v_fmac_f32_dpp v106, v13, v42 row_newbcast:8 row_mask:0xf bank_mask:0xf
  v_fmac_f32_dpp v107, v13, v43 row_newbcast:8 row_mask:0xf bank_mask:0xf
  v_lshlrev_b32 v44, 16, v130
  v_and_b32 v45, s12, v130
  v_lshlrev_b32 v46, 16, v131
  v_and_b32 v47, s12, v131
  v_fmac_f32_dpp v100, v12, v44 row_newbcast:9 row_mask:0xf bank_mask:0xf
  v_fmac_f32_dpp v101, v12, v45 row_newbcast:9 row_mask:0xf bank_mask:0xf
  v_fmac_f32_dpp v102, v12, v46 row_newbcast:9 row_mask:0xf bank_mask:0xf
  v_fmac_f32_dpp v103, v12, v47 row_newbcast:9 row_mask:0xf bank_mask:0xf
  v_fmac_f32_dpp v104, v13, v44 row_newbcast:9 row_mask:0xf bank_mask:0xf
  v_fmac_f32_dpp v105, v13, v45 row_newbcast:9 row_mask:0xf bank_mask:0xf
  v_fmac_f32_dpp v106, v13, v46 row_newbcast:9 row_mask:0xf bank_mask:0xf
  v_fmac_f32_dpp v107, v13, v47 row_newbcast:9 row_mask:0xf bank_mask:0xf
  s_cmp_le_u32 s15, 40
  s_cbranch_scc1 L_wd_c
  v_lshlrev_b32 v40, 16, v132
  v_and_b32 v41, s12, v132
  v_lshlrev_b32 v42, 16, v133
  v_and_b32 v43, s12, v133
  v_fmac_f32_dpp v100, v12, v40 row_newbcast:10 row_mask:0xf bank_mask:0xf
  v_fmac_f32_dpp v101, v12, v41 row_newbcast:10 row_mask:0xf bank_mask:0xf
  v_fmac_f32_dpp v102, v12, v42 row_newbcast:10 row_mask:0xf bank_mask:0xf
  v_fmac_f32_dpp v103, v12, v43 row_newbcast:10 row_mask:0xf bank_mask:0xf
  v_fmac_f32_dpp v104, v13, v40 row_newbcast:10 row_mask:0xf bank_mask:0xf
  v_fmac_f32_dpp v105, v13, v41 row_newbcast:10 row_mask:0xf bank_mask:0xf
  v_fmac_f32_dpp v106, v13, v42 row_newbcast:10 row_mask:0xf bank_mask:0xf
  v_fmac_f32_dpp v107, v13, v43 row_newbcast:10 row_mask:0xf bank_mask:0xf
  v_lshlrev_b32 v44, 16, v134
  v_and_b32 v45, s12, v134
  v_lshlrev_b32 v46, 16, v135
  v_and_b32 v47, s12, v135
  v_fmac_f32_dpp v100, v12, v44 row_newbcast:11 row_mask:0xf bank_mask:0xf
  v_fmac_f32_dpp v101, v12, v45 row_newbcast:11 row_mask:0xf bank_mask:0xf
  v_fmac_f32_dpp v102, v12, v46 row_newbcast:11 row_mask:0xf bank_mask:0xf
  v_fmac_f32_dpp v103, v12, v47 row_newbcast:11 row_mask:0xf bank_mask:0xf
  v_fmac_f32_dpp v104, v13, v44 row_newbcast:11 row_mask:0xf bank_mask:0xf
  v_fmac_f32_dpp v105, v13, v45 row_newbcast:11 row_mask:0xf bank_mask:0xf
  v_fmac_f32_dpp v106, v13, v46 row_newbcast:11 row_mask:0xf bank_mask:0xf
  v_fmac_f32_dpp v107, v13, v47 row_newbcast:11 row_mask:0xf bank_mask:0xf
L_wd_c:
  v_permlane32_swap_b32 v100, v104
  v_permlane32_swap_b32 v101, v105
  v_permlane32_swap_b32 v102, v106
  v_permlane32_swap_b32 v103, v107
  v_add_f32 v100, v100, v104
  v_add_f32 v101, v101, v105
  v_add_f32 v102, v102, v106
  v_add_f32 v103, v103, v107
  s_nop 0
  v_permlane16_swap_b32 v100, v102
  v_permlane16_swap_b32 v101, v103
  v_add_f32 v100, v100, v102
  v_add_f32 v101, v101, v103
  v_lshlrev_b32 v15, 1, v15
  s_mov_b32 s68, 0
  s_mov_b32 s69, 0x41b80000
  v_cvt_f64_f32 v[32:33], v100
  v_cvt_f64_f32 v[34:35], v101
  v_add_f64 v[36:37], v[32:33], s[68:69]
  v_add_f64 v[38:39], v[34:35], s[68:69]
  v_add_f64 v[32:33], v[32:33], -s[68:69]
  v_add_f64 v[34:35], v[34:35], -s[68:69]
  v_add_u32 v37, 0xc2480000, v37
  v_add_u32 v39, 0xc2480000, v39
  ds_write_b128 v15, v[36:39] offset:6144
  ds_write_b128 v15, v[32:35] offset:7168
  s_waitcnt lgkmcnt(0)
L_end:
  s_endpgm
L_smain_e:
  s_mov_b32 s46, 0x100000
  s_mov_b32 s47, 0x20000
  s_add_u32 s44, s20, s8
  s_addc_u32 s45, s21, 0
  v_and_b32 v16, 15, v0
  v_lshlrev_b32 v16, 4, v16
  s_mov_b32 s66, 0x22222222
  s_mov_b32 s67, 0x22222222
  s_mov_b32 s68, 0x44444444
  s_mov_b32 s69, 0x44444444
  s_mov_b32 s10, 0x88888888
  s_mov_b32 s11, 0x88888888
  s_mov_b32 s12, 0xffff0000
  s_mov_b32 s15, 0
  s_waitcnt vmcnt(2)
  s_mov_b32 s64, 2560
  buffer_load_dwordx4 v[40:43], v1, s[40:43], s64 offen nt
  s_memrealtime s[22:23]
L_pce4:
  s_waitcnt lgkmcnt(0)
  s_sub_u32 s26, s22, s24
  s_cmp_lt_u32 s26, 120
  s_cbranch_scc1 L_pcwe4
  s_mov_b32 s64, 524288
  buffer_load_dwordx4 v[44:47], v1, s[40:43], s64 offen nt
  s_memrealtime s[22:23]
L_pce5:
  s_waitcnt lgkmcnt(0)
  s_sub_u32 s26, s22, s24
  s_cmp_lt_u32 s26, 161
  s_cbranch_scc1 L_pcwe5
  s_mov_b32 s64, 526336
  buffer_load_dwordx4 v[48:51], v1, s[40:43], s64 offen nt
  s_memrealtime s[22:23]
  s_waitcnt vmcnt(4)
L_pce6:
  s_waitcnt lgkmcnt(0)
  s_sub_u32 s26, s22, s24
  s_cmp_lt_u32 s26, 201
  s_cbranch_scc1 L_pcwe6
  s_mov_b32 s64, 524800
  buffer_load_dwordx4 v[52:55], v1, s[40:43], s64 offen nt
  s_memrealtime s[22:23]
  s_waitcnt vmcnt(4)
L_pce7:
  s_waitcnt lgkmcnt(0)
  s_sub_u32 s26, s22, s24
  s_cmp_lt_u32 s26, 242
  s_cbranch_scc1 L_pcwe7
  s_mov_b32 s64, 526848
  buffer_load_dwordx4 v[56:59], v1, s[40:43], s64 offen nt
  s_memrealtime s[22:23]
  s_waitcnt vmcnt(4)
L_pce8:
  s_waitcnt lgkmcnt(0)
  s_sub_u32 s26, s22, s24
  s_cmp_lt_u32 s26, 282
  s_cbranch_scc1 L_pcwe8
  s_mov_b32 s64, 262144
  buffer_load_dwordx4 v[60:63], v1, s[40:43], s64 offen nt
  s_memrealtime s[22:23]
  s_waitcnt vmcnt(4)
L_pce9:
  s_waitcnt lgkmcnt(0)
  s_sub_u32 s26, s22, s24
  s_cmp_lt_u32 s26, 323
  s_cbranch_scc1 L_pcwe9
  s_mov_b32 s64, 264192
  buffer_load_dwordx4 v[64:67], v1, s[40:43], s64 offen nt
  s_memrealtime s[22:23]
  s_waitcnt vmcnt(4)
L_pce10:
  s_waitcnt lgkmcnt(0)
  s_sub_u32 s26, s22, s24
  s_cmp_lt_u32 s26, 364
  s_cbranch_scc1 L_pcwe10
  s_mov_b32 s64, 262656
  buffer_load_dwordx4 v[68:71], v1, s[40:43], s64 offen nt
  s_memrealtime s[22:23]
  s_waitcnt vmcnt(4)
L_pce11:
  s_waitcnt lgkmcnt(0)
  s_sub_u32 s26, s22, s24
  s_cmp_lt_u32 s26, 404
  s_cbranch_scc1 L_pcwe11
  s_mov_b32 s64, 264704
  buffer_load_dwordx4 v[72:75], v1, s[40:43], s64 offen nt
  s_memrealtime s[22:23]
  s_waitcnt vmcnt(4)
L_pce12:
  s_waitcnt lgkmcnt(0)
  s_sub_u32 s26, s22, s24
  s_cmp_lt_u32 s26, 445
  s_cbranch_scc1 L_pcwe12
  s_mov_b32 s64, 786432
  buffer_load_dwordx4 v[76:79], v1, s[40:43], s64 offen nt
  s_memrealtime s[22:23]
  s_waitcnt vmcnt(4)
L_pce13:
  s_waitcnt lgkmcnt(0)
  s_sub_u32 s26, s22, s24
  s_cmp_lt_u32 s26, 472
  s_cbranch_scc1 L_pcwe13
  s_mov_b32 s64, 788480
  buffer_load_dwordx4 v[80:83], v1, s[40:43], s64 offen nt
  s_memrealtime s[22:23]
  s_waitcnt vmcnt(4)
L_pce14:
  s_waitcnt lgkmcnt(0)
  s_sub_u32 s26, s22, s24
  s_cmp_lt_u32 s26, 498
  s_cbranch_scc1 L_pcwe14
  s_mov_b32 s64, 786944
  buffer_load_dwordx4 v[84:87], v1, s[40:43], s64 offen nt
  s_memrealtime s[22:23]
  s_waitcnt vmcnt(4)
L_pce15:
  s_waitcnt lgkmcnt(0)
  s_sub_u32 s26, s22, s24
  s_cmp_lt_u32 s26, 525
  s_cbranch_scc1 L_pcwe15
  s_mov_b32 s64, 788992
  buffer_load_dwordx4 v[88:91], v1, s[40:43], s64 offen nt
  s_memrealtime s[22:23]
  s_waitcnt vmcnt(4)
  s_waitcnt lgkmcnt(0)
  s_sub_u32 s26, s22, s24
  s_cmp_lt_u32 s26, 552
  s_cbranch_scc1 L_pcwe16
  s_add_u32 s24, s24, 1
  s_add_u32 s15, s15, 1
L_pce16:
  s_mov_b32 s64, 131072
  buffer_load_dwordx4 v[92:95], v1, s[40:43], s64 offen nt
  s_memrealtime s[22:23]
  s_waitcnt vmcnt(4)
  s_waitcnt lgkmcnt(0)
  s_sub_u32 s26, s22, s24
  s_cmp_lt_u32 s26, 578
  s_cbranch_scc1 L_pcwe17
  s_add_u32 s24, s24, 1
  s_add_u32 s15, s15, 1
L_pce17:
  s_mov_b32 s64, 133120
  buffer_load_dwordx4 v[96:99], v1, s[40:43], s64 offen nt
  s_memrealtime s[22:23]
  s_waitcnt vmcnt(4)
  s_waitcnt lgkmcnt(0)
  s_sub_u32 s26, s22, s24
  s_cmp_lt_u32 s26, 604
  s_cbranch_scc1 L_pcwe18
  s_add_u32 s24, s24, 1
  s_add_u32 s15, s15, 1
L_pce18:
  s_mov_b32 s64, 131584
  buffer_load_dwordx4 v[100:103], v1, s[40:43], s64 offen nt
  s_memrealtime s[22:23]
  s_waitcnt vmcnt(4)
  s_waitcnt lgkmcnt(0)
  s_sub_u32 s26, s22, s24
  s_cmp_lt_u32 s26, 630
  s_cbranch_scc1 L_pcwe19
  s_add_u32 s24, s24, 1
  s_add_u32 s15, s15, 1
L_pce19:
  s_mov_b32 s64, 133632
  buffer_load_dwordx4 v[104:107], v1, s[40:43], s64 offen nt
  s_memrealtime s[22:23]
  s_waitcnt vmcnt(4)
  s_waitcnt lgkmcnt(0)
  s_sub_u32 s26, s22, s24
  s_cmp_lt_u32 s26, 656
  s_cbranch_scc1 L_pcwe20
  s_add_u32 s24, s24, 1
  s_add_u32 s15, s15, 1
L_pce20:
  s_mov_b32 s64, 655360
  buffer_load_dwordx4 v[108:111], v1, s[40:43], s64 offen nt
  s_memrealtime s[22:23]
  s_waitcnt vmcnt(4)
  s_waitcnt lgkmcnt(0)
  s_sub_u32 s26, s22, s24
  s_cmp_lt_u32 s26, 682
  s_cbranch_scc1 L_pcwe21
  s_add_u32 s24, s24, 1
  s_add_u32 s15, s15, 1
L_pce21:
  s_mov_b32 s64, 657408
  buffer_load_dwordx4 v[112:115], v1, s[40:43], s64 offen nt
  s_memrealtime s[22:23]
  s_waitcnt vmcnt(4)
  s_waitcnt lgkmcnt(0)
  s_sub_u32 s26, s22, s24
  s_cmp_lt_u32 s26, 708
  s_cbranch_scc1 L_pcwe22
  s_add_u32 s24, s24, 1
  s_add_u32 s15, s15, 1
L_pce22:
  s_mov_b32 s64, 655872
  buffer_load_dwordx4 v[116:119], v1, s[40:43], s64 offen nt
  s_memrealtime s[22:23]
  s_waitcnt vmcnt(4)
  s_waitcnt lgkmcnt(0)
  s_sub_u32 s26, s22, s24
  s_cmp_lt_u32 s26, 734
  s_cbranch_scc1 L_pcwe23
  s_add_u32 s24, s24, 1
  s_add_u32 s15, s15, 1
L_pce23:
  s_mov_b32 s64, 657920
  buffer_load_dwordx4 v[120:123], v1, s[40:43], s64 offen nt
  s_memrealtime s[22:23]
  s_waitcnt vmcnt(4)
  s_waitcnt lgkmcnt(0)
  s_sub_u32 s26, s22, s24
  s_cmp_lt_u32 s26, 760
  s_cbranch_scc1 L_pcwe24
  s_add_u32 s24, s24, 1
  s_add_u32 s15, s15, 1
L_pce24:
  s_mov_b32 s64, 393216
  buffer_load_dwordx4 v[124:127], v1, s[40:43], s64 offen nt
  s_memrealtime s[22:23]
  s_waitcnt vmcnt(4)
  s_waitcnt lgkmcnt(0)
  s_sub_u32 s26, s22, s24
  s_cmp_lt_u32 s26, 786
  s_cbranch_scc1 L_pcwe25
  s_add_u32 s24, s24, 1
  s_add_u32 s15, s15, 1
L_pce25:
  s_mov_b32 s64, 395264
  buffer_load_dwordx4 v[128:131], v1, s[40:43], s64 offen nt
  s_memrealtime s[22:23]
  s_waitcnt vmcnt(4)
  s_waitcnt lgkmcnt(0)
  s_sub_u32 s26, s22, s24
  s_cmp_lt_u32 s26, 812
  s_cbranch_scc1 L_pcwe26
  s_add_u32 s24, s24, 1
  s_add_u32 s15, s15, 1
L_pce26:
  s_mov_b32 s64, 393728
  buffer_load_dwordx4 v[132:135], v1, s[40:43], s64 offen nt
  s_memrealtime s[22:23]
  s_waitcnt vmcnt(4)
  s_waitcnt lgkmcnt(0)
  s_sub_u32 s26, s22, s24
  s_cmp_lt_u32 s26, 838
  s_cbranch_scc1 L_pcwe27
  s_add_u32 s24, s24, 1
  s_add_u32 s15, s15, 1
L_pce27:
  s_mov_b32 s64, 395776
  buffer_load_dwordx4 v[136:139], v1, s[40:43], s64 offen nt
  s_memrealtime s[22:23]
  s_waitcnt vmcnt(4)
  s_waitcnt lgkmcnt(0)
  s_sub_u32 s26, s22, s24
  s_cmp_lt_u32 s26, 863
  s_cbranch_scc1 L_pcwe28
  s_add_u32 s24, s24, 1
  s_add_u32 s15, s15, 1
L_pce28:
  s_mov_b32 s64, 917504
  buffer_load_dwordx4 v[140:143], v1, s[40:43], s64 offen nt
  s_memrealtime s[22:23]
  s_waitcnt vmcnt(4)
  s_waitcnt lgkmcnt(0)
  s_sub_u32 s26, s22, s24
  s_cmp_lt_u32 s26, 889
  s_cbranch_scc1 L_pcwe29
  s_add_u32 s24, s24, 1
  s_add_u32 s15, s15, 1
L_pce29:
  s_mov_b32 s64, 919552
  buffer_load_dwordx4 v[144:147], v1, s[40:43], s64 offen nt
  s_memrealtime s[22:23]
  s_waitcnt vmcnt(4)
  s_waitcnt lgkmcnt(0)
  s_sub_u32 s26, s22, s24
  s_cmp_lt_u32 s26, 915
  s_cbranch_scc1 L_pcwe30
  s_add_u32 s24, s24, 1
  s_add_u32 s15, s15, 1
L_pce30:
  s_mov_b32 s64, 918016
  buffer_load_dwordx4 v[148:151], v1, s[40:43], s64 offen nt
  s_memrealtime s[22:23]
  s_waitcnt vmcnt(4)
  s_waitcnt lgkmcnt(0)
  s_sub_u32 s26, s22, s24
  s_cmp_lt_u32 s26, 941
  s_cbranch_scc1 L_pcwe31
  s_add_u32 s24, s24, 1
  s_add_u32 s15, s15, 1
L_pce31:
  s_mov_b32 s64, 920064
  buffer_load_dwordx4 v[152:155], v1, s[40:43], s64 offen nt
  s_memrealtime s[22:23]
  s_mov_b32 s13, 2097152
L_qs_se:
  ds_read_b128 v[2:5], v16 offset:0
  s_waitcnt lgkmcnt(0)
  v_max3_u32 v17, v2, v3, v4
  v_max_u32 v17, v17, v5
  v_cmp_eq_u32 vcc, -1, v17
  s_cbranch_vccz L_qo_se
  s_sleep 2
  s_sub_u32 s13, s13, 1
  s_cbranch_scc0 L_qs_se
L_qo_se:
  v_mov_b32 v17, 0
  ds_read_b32 v17, v17 offset:384
  s_waitcnt lgkmcnt(0)
  v_readfirstlane_b32 s26, v17
  s_add_u32 s27, s26, s15
  s_cmp_eq_u32 s26, -1
  s_cselect_b32 s24, s24, s27
  v_dot2_f32_bf16 v8, v28, v2, 0
  v_dot2_f32_bf16 v9, v32, v2, 0
  v_dot2_f32_bf16 v10, v36, v2, 0
  v_dot2_f32_bf16 v11, v40, v2, 0
  v_dot2_f32_bf16 v8, v29, v3, v8
  v_dot2_f32_bf16 v9, v33, v3, v9
  v_dot2_f32_bf16 v10, v37, v3, v10
  v_dot2_f32_bf16 v11, v41, v3, v11
  v_dot2_f32_bf16 v8, v30, v4, v8
  v_dot2_f32_bf16 v9, v34, v4, v9
  v_dot2_f32_bf16 v10, v38, v4, v10
  v_dot2_f32_bf16 v11, v42, v4, v11
  v_dot2_f32_bf16 v8, v31, v5, v8
  v_dot2_f32_bf16 v9, v35, v5, v9
  v_dot2_f32_bf16 v10, v39, v5, v10
  v_dot2_f32_bf16 v11, v43, v5, v11
  s_waitcnt vmcnt(4)
  s_waitcnt lgkmcnt(0)
  s_sub_u32 s26, s22, s24
  s_cmp_lt_u32 s26, 967
  s_cbranch_scc1 L_pcwe32
  s_add_u32 s24, s24, 1
  s_add_u32 s15, s15, 1
L_pce32:
  s_mov_b32 s64, 0
  buffer_load_dwordx4 v[156:159], v1, s[44:47], s64 offen nt
  s_memrealtime s[22:23]
  v_dot2_f32_bf16 v12, v44, v2, 0
  v_dot2_f32_bf16 v13, v48, v2, 0
  v_add_f32_dpp v8, v8, v8 row_ror:8 row_mask:0xf bank_mask:0x3
  v_dot2_f32_bf16 v14, v52, v2, 0
  v_dot2_f32_bf16 v15, v56, v2, 0
  v_add_f32_dpp v10, v10, v10 row_ror:8 row_mask:0xf bank_mask:0x3
  v_dot2_f32_bf16 v12, v45, v3, v12
  v_dot2_f32_bf16 v13, v49, v3, v13
  v_add_f32_dpp v8, v9, v9 row_ror:8 row_mask:0xf bank_mask:0xc
  v_dot2_f32_bf16 v14, v53, v3, v14
  v_dot2_f32_bf16 v15, v57, v3, v15
  v_add_f32_dpp v10, v11, v11 row_ror:8 row_mask:0xf bank_mask:0xc
  v_dot2_f32_bf16 v12, v46, v4, v12
  v_dot2_f32_bf16 v13, v50, v4, v13
  v_add_f32_dpp v8, v8, v8 row_shl:4 row_mask:0xf bank_mask:0x5
  v_dot2_f32_bf16 v14, v54, v4, v14
  v_dot2_f32_bf16 v15, v58, v4, v15
  v_add_f32_dpp v8, v10, v10 row_shr:4 row_mask:0xf bank_mask:0xa
  v_dot2_f32_bf16 v12, v47, v5, v12
  v_dot2_f32_bf16 v13, v51, v5, v13
  v_add_f32_dpp v8, v8, v8 quad_perm:[2,3,0,1] row_mask:0xf bank_mask:0xf
  v_dot2_f32_bf16 v14, v55, v5, v14
  v_dot2_f32_bf16 v15, v59, v5, v15
  v_add_f32_dpp v6, v8, v8 quad_perm:[1,0,3,2] row_mask:0xf bank_mask:0xf
  s_waitcnt vmcnt(4)
  s_waitcnt lgkmcnt(0)
  s_sub_u32 s26, s22, s24
  s_cmp_lt_u32 s26, 993
  s_cbranch_scc1 L_pcwe33
  s_add_u32 s24, s24, 1
  s_add_u32 s15, s15, 1
L_pce33:
  s_mov_b32 s64, 2048
  buffer_load_dwordx4 v[160:163], v1, s[44:47], s64 offen nt
  s_memrealtime s[22:23]
  v_dot2_f32_bf16 v8, v60, v2, 0
  v_dot2_f32_bf16 v9, v64, v2, 0
  v_add_f32_dpp v12, v12, v12 row_ror:8 row_mask:0xf bank_mask:0x3
  v_dot2_f32_bf16 v10, v68, v2, 0
  v_dot2_f32_bf16 v11, v72, v2, 0
  v_add_f32_dpp v14, v14, v14 row_ror:8 row_mask:0xf bank_mask:0x3
  v_dot2_f32_bf16 v8, v61, v3, v8
  v_dot2_f32_bf16 v9, v65, v3, v9
  v_add_f32_dpp v12, v13, v13 row_ror:8 row_mask:0xf bank_mask:0xc
  v_dot2_f32_bf16 v10, v69, v3, v10
  v_dot2_f32_bf16 v11, v73, v3, v11
  v_add_f32_dpp v14, v15, v15 row_ror:8 row_mask:0xf bank_mask:0xc
  v_dot2_f32_bf16 v8, v62, v4, v8
  v_dot2_f32_bf16 v9, v66, v4, v9
  v_add_f32_dpp v12, v12, v12 row_shl:4 row_mask:0xf bank_mask:0x5
  v_dot2_f32_bf16 v10, v70, v4, v10
  v_dot2_f32_bf16 v11, v74, v4, v11
  v_add_f32_dpp v12, v14, v14 row_shr:4 row_mask:0xf bank_mask:0xa
  v_dot2_f32_bf16 v8, v63, v5, v8
  v_dot2_f32_bf16 v9, v67, v5, v9
  v_add_f32_dpp v12, v12, v12 quad_perm:[2,3,0,1] row_mask:0xf bank_mask:0xf
  v_dot2_f32_bf16 v10, v71, v5, v10
  v_dot2_f32_bf16 v11, v75, v5, v11
  v_add_f32_dpp v12, v12, v12 quad_perm:[1,0,3,2] row_mask:0xf bank_mask:0xf
  v_cndmask_b32 v6, v6, v12, s[66:67]
  s_waitcnt vmcnt(4)
  s_waitcnt lgkmcnt(0)
  s_sub_u32 s26, s22, s24
  s_cmp_lt_u32 s26, 1019
  s_cbranch_scc1 L_pcwe34
  s_add_u32 s24, s24, 1
  s_add_u32 s15, s15, 1
L_pce34:
  s_mov_b32 s64, 512
  buffer_load_dwordx4 v[164:167], v1, s[44:47], s64 offen nt
  s_memrealtime s[22:23]
  v_dot2_f32_bf16 v12, v76, v2, 0
  v_dot2_f32_bf16 v13, v80, v2, 0
  v_add_f32_dpp v8, v8, v8 row_ror:8 row_mask:0xf bank_mask:0x3
  v_dot2_f32_bf16 v14, v84, v2, 0
  v_dot2_f32_bf16 v15, v88, v2, 0
  v_add_f32_dpp v10, v10, v10 row_ror:8 row_mask:0xf bank_mask:0x3
  v_dot2_f32_bf16 v12, v77, v3, v12
  v_dot2_f32_bf16 v13, v81, v3, v13
  v_add_f32_dpp v8, v9, v9 row_ror:8 row_mask:0xf bank_mask:0xc
  v_dot2_f32_bf16 v14, v85, v3, v14
  v_dot2_f32_bf16 v15, v89, v3, v15
  v_add_f32_dpp v10, v11, v11 row_ror:8 row_mask:0xf bank_mask:0xc
  v_dot2_f32_bf16 v12, v78, v4, v12
  v_dot2_f32_bf16 v13, v82, v4, v13
  v_add_f32_dpp v8, v8, v8 row_shl:4 row_mask:0xf bank_mask:0x5
  v_dot2_f32_bf16 v14, v86, v4, v14
  v_dot2_f32_bf16 v15, v90, v4, v15
  v_add_f32_dpp v8, v10, v10 row_shr:4 row_mask:0xf bank_mask:0xa
  v_dot2_f32_bf16 v12, v79, v5, v12
  v_dot2_f32_bf16 v13, v83, v5, v13
  v_add_f32_dpp v8, v8, v8 quad_perm:[2,3,0,1] row_mask:0xf bank_mask:0xf
  v_dot2_f32_bf16 v14, v87, v5, v14
  v_dot2_f32_bf16 v15, v91, v5, v15
  v_add_f32_dpp v8, v8, v8 quad_perm:[1,0,3,2] row_mask:0xf bank_mask:0xf
  v_cndmask_b32 v6, v6, v8, s[68:69]
  s_waitcnt vmcnt(4)
  s_waitcnt lgkmcnt(0)
  s_sub_u32 s26, s22, s24
  s_cmp_lt_u32 s26, 1045
  s_cbranch_scc1 L_pcwe35
  s_add_u32 s24, s24, 1
  s_add_u32 s15, s15, 1
L_pce35:
  s_mov_b32 s64, 2560
  buffer_load_dwordx4 v[28:31], v1, s[44:47], s64 offen nt
  s_memrealtime s[22:23]
  v_dot2_f32_bf16 v8, v92, v2, 0
  v_dot2_f32_bf16 v9, v96, v2, 0
  v_add_f32_dpp v12, v12, v12 row_ror:8 row_mask:0xf bank_mask:0x3
  v_dot2_f32_bf16 v10, v100, v2, 0
  v_dot2_f32_bf16 v11, v104, v2, 0
  v_add_f32_dpp v14, v14, v14 row_ror:8 row_mask:0xf bank_mask:0x3
  v_dot2_f32_bf16 v8, v93, v3, v8
  v_dot2_f32_bf16 v9, v97, v3, v9
  v_add_f32_dpp v12, v13, v13 row_ror:8 row_mask:0xf bank_mask:0xc
  v_dot2_f32_bf16 v10, v101, v3, v10
  v_dot2_f32_bf16 v11, v105, v3, v11
  v_add_f32_dpp v14, v15, v15 row_ror:8 row_mask:0xf bank_mask:0xc
  v_dot2_f32_bf16 v8, v94, v4, v8
  v_dot2_f32_bf16 v9, v98, v4, v9
  v_add_f32_dpp v12, v12, v12 row_shl:4 row_mask:0xf bank_mask:0x5
  v_dot2_f32_bf16 v10, v102, v4, v10
  v_dot2_f32_bf16 v11, v106, v4, v11
  v_add_f32_dpp v12, v14, v14 row_shr:4 row_mask:0xf bank_mask:0xa
  v_dot2_f32_bf16 v8, v95, v5, v8
  v_dot2_f32_bf16 v9, v99, v5, v9
  v_add_f32_dpp v12, v12, v12 quad_perm:[2,3,0,1] row_mask:0xf bank_mask:0xf
  v_dot2_f32_bf16 v10, v103, v5, v10
  v_dot2_f32_bf16 v11, v107, v5, v11
  v_add_f32_dpp v12, v12, v12 quad_perm:[1,0,3,2] row_mask:0xf bank_mask:0xf
  v_cndmask_b32 v6, v6, v12, s[10:11]
  s_waitcnt vmcnt(4)
  s_waitcnt lgkmcnt(0)
  s_sub_u32 s26, s22, s24
  s_cmp_lt_u32 s26, 1071
  s_cbranch_scc1 L_pcwe36
  s_add_u32 s24, s24, 1
  s_add_u32 s15, s15, 1
L_pce36:
  s_mov_b32 s64, 524288
  buffer_load_dwordx4 v[32:35], v1, s[44:47], s64 offen nt
  s_memrealtime s[22:23]
  v_dot2_f32_bf16 v12, v108, v2, 0
  v_dot2_f32_bf16 v13, v112, v2, 0
  v_add_f32_dpp v8, v8, v8 row_ror:8 row_mask:0xf bank_mask:0x3
  v_dot2_f32_bf16 v14, v116, v2, 0
  v_dot2_f32_bf16 v15, v120, v2, 0
  v_add_f32_dpp v10, v10, v10 row_ror:8 row_mask:0xf bank_mask:0x3
  v_dot2_f32_bf16 v12, v109, v3, v12
  v_dot2_f32_bf16 v13, v113, v3, v13
  v_add_f32_dpp v8, v9, v9 row_ror:8 row_mask:0xf bank_mask:0xc
  v_dot2_f32_bf16 v14, v117, v3, v14
  v_dot2_f32_bf16 v15, v121, v3, v15
  v_add_f32_dpp v10, v11, v11 row_ror:8 row_mask:0xf bank_mask:0xc
  v_dot2_f32_bf16 v12, v110, v4, v12
  v_dot2_f32_bf16 v13, v114, v4, v13
  v_add_f32_dpp v8, v8, v8 row_shl:4 row_mask:0xf bank_mask:0x5
  v_dot2_f32_bf16 v14, v118, v4, v14
  v_dot2_f32_bf16 v15, v122, v4, v15
  v_add_f32_dpp v8, v10, v10 row_shr:4 row_mask:0xf bank_mask:0xa
  v_dot2_f32_bf16 v12, v111, v5, v12
  v_dot2_f32_bf16 v13, v115, v5, v13
  v_add_f32_dpp v8, v8, v8 quad_perm:[2,3,0,1] row_mask:0xf bank_mask:0xf
  v_dot2_f32_bf16 v14, v119, v5, v14
  v_dot2_f32_bf16 v15, v123, v5, v15
  v_add_f32_dpp v7, v8, v8 quad_perm:[1,0,3,2] row_mask:0xf bank_mask:0xf
  s_waitcnt vmcnt(4)
  s_waitcnt lgkmcnt(0)
  s_sub_u32 s26, s22, s24
  s_cmp_lt_u32 s26, 1097
  s_cbranch_scc1 L_pcwe37
  s_add_u32 s24, s24, 1
  s_add_u32 s15, s15, 1
L_pce37:
  s_mov_b32 s64, 526336
  buffer_load_dwordx4 v[36:39], v1, s[44:47], s64 offen nt
  s_memrealtime s[22:23]
  v_dot2_f32_bf16 v8, v124, v2, 0
  v_dot2_f32_bf16 v9, v128, v2, 0
  v_add_f32_dpp v12, v12, v12 row_ror:8 row_mask:0xf bank_mask:0x3
  v_dot2_f32_bf16 v10, v132, v2, 0
  v_dot2_f32_bf16 v11, v136, v2, 0
  v_add_f32_dpp v14, v14, v14 row_ror:8 row_mask:0xf bank_mask:0x3
  v_dot2_f32_bf16 v8, v125, v3, v8
  v_dot2_f32_bf16 v9, v129, v3, v9
  v_add_f32_dpp v12, v13, v13 row_ror:8 row_mask:0xf bank_mask:0xc
  v_dot2_f32_bf16 v10, v133, v3, v10
  v_dot2_f32_bf16 v11, v137, v3, v11
  v_add_f32_dpp v14, v15, v15 row_ror:8 row_mask:0xf bank_mask:0xc
  v_dot2_f32_bf16 v8, v126, v4, v8
  v_dot2_f32_bf16 v9, v130, v4, v9
  v_add_f32_dpp v12, v12, v12 row_shl:4 row_mask:0xf bank_mask:0x5
  v_dot2_f32_bf16 v10, v134, v4, v10
  v_dot2_f32_bf16 v11, v138, v4, v11
  v_add_f32_dpp v12, v14, v14 row_shr:4 row_mask:0xf bank_mask:0xa
  v_dot2_f32_bf16 v8, v127, v5, v8
  v_dot2_f32_bf16 v9, v131, v5, v9
  v_add_f32_dpp v12, v12, v12 quad_perm:[2,3,0,1] row_mask:0xf bank_mask:0xf
  v_dot2_f32_bf16 v10, v135, v5, v10
  v_dot2_f32_bf16 v11, v139, v5, v11
  v_add_f32_dpp v12, v12, v12 quad_perm:[1,0,3,2] row_mask:0xf bank_mask:0xf
  v_cndmask_b32 v7, v7, v12, s[66:67]
  s_waitcnt vmcnt(4)
  s_waitcnt lgkmcnt(0)
  s_sub_u32 s26, s22, s24
  s_cmp_lt_u32 s26, 1123
  s_cbranch_scc1 L_pcwe38
  s_add_u32 s24, s24, 1
  s_add_u32 s15, s15, 1
L_pce38:
  s_mov_b32 s64, 524800
  buffer_load_dwordx4 v[40:43], v1, s[44:47], s64 offen nt
  s_memrealtime s[22:23]
  v_dot2_f32_bf16 v12, v140, v2, 0
  v_dot2_f32_bf16 v13, v144, v2, 0
  v_add_f32_dpp v8, v8, v8 row_ror:8 row_mask:0xf bank_mask:0x3
  v_dot2_f32_bf16 v14, v148, v2, 0
  v_dot2_f32_bf16 v15, v152, v2, 0
  v_add_f32_dpp v10, v10, v10 row_ror:8 row_mask:0xf bank_mask:0x3
  v_dot2_f32_bf16 v12, v141, v3, v12
  v_dot2_f32_bf16 v13, v145, v3, v13
  v_add_f32_dpp v8, v9, v9 row_ror:8 row_mask:0xf bank_mask:0xc
  v_dot2_f32_bf16 v14, v149, v3, v14
  v_dot2_f32_bf16 v15, v153, v3, v15
  v_add_f32_dpp v10, v11, v11 row_ror:8 row_mask:0xf bank_mask:0xc
  v_dot2_f32_bf16 v12, v142, v4, v12
  v_dot2_f32_bf16 v13, v146, v4, v13
  v_add_f32_dpp v8, v8, v8 row_shl:4 row_mask:0xf bank_mask:0x5
  v_dot2_f32_bf16 v14, v150, v4, v14
  v_dot2_f32_bf16 v15, v154, v4, v15
  v_add_f32_dpp v8, v10, v10 row_shr:4 row_mask:0xf bank_mask:0xa
  v_dot2_f32_bf16 v12, v143, v5, v12
  v_dot2_f32_bf16 v13, v147, v5, v13
  v_add_f32_dpp v8, v8, v8 quad_perm:[2,3,0,1] row_mask:0xf bank_mask:0xf
  v_dot2_f32_bf16 v14, v151, v5, v14
  v_dot2_f32_bf16 v15, v155, v5, v15
  v_add_f32_dpp v8, v8, v8 quad_perm:[1,0,3,2] row_mask:0xf bank_mask:0xf
  v_cndmask_b32 v7, v7, v8, s[68:69]
  s_waitcnt vmcnt(4)
  s_waitcnt lgkmcnt(0)
  s_sub_u32 s26, s22, s24
  s_cmp_lt_u32 s26, 1149
  s_cbranch_scc1 L_pcwe39
  s_add_u32 s24, s24, 1
  s_add_u32 s15, s15, 1
L_pce39:
  s_mov_b32 s64, 526848
  buffer_load_dwordx4 v[44:47], v1, s[44:47], s64 offen nt
  s_memrealtime s[22:23]
  v_add_f32_dpp v12, v12, v12 row_ror:8 row_mask:0xf bank_mask:0x3
  v_add_f32_dpp v14, v14, v14 row_ror:8 row_mask:0xf bank_mask:0x3
  s_nop 0
  v_add_f32_dpp v12, v13, v13 row_ror:8 row_mask:0xf bank_mask:0xc
  v_add_f32_dpp v14, v15, v15 row_ror:8 row_mask:0xf bank_mask:0xc
  s_nop 0
  v_add_f32_dpp v12, v12, v12 row_shl:4 row_mask:0xf bank_mask:0x5
  s_nop 1
  v_add_f32_dpp v12, v14, v14 row_shr:4 row_mask:0xf bank_mask:0xa
  s_nop 1
  v_add_f32_dpp v12, v12, v12 quad_perm:[2,3,0,1] row_mask:0xf bank_mask:0xf
  s_nop 1
  v_add_f32_dpp v12, v12, v12 quad_perm:[1,0,3,2] row_mask:0xf bank_mask:0xf
  v_cndmask_b32 v7, v7, v12, s[10:11]
  s_mov_b32 s13, 0x3db504f3
  v_cvt_pk_bf16_f32 v16, v6, v7
  v_lshlrev_b32 v6, 16, v16
  v_and_b32 v7, s12, v16
  v_mul_f32 v6, s13, v6
  v_mul_f32 v7, s13, v7
  v_cvt_pk_bf16_f32 v16, v6, v7
  v_lshlrev_b32 v6, 16, v16
  v_and_b32 v7, s12, v16
  v_max_f32 v18, v6, v7
  s_nop 1
  v_max_f32_dpp v18, v18, v18 row_ror:8 row_mask:0xf bank_mask:0xf
  s_nop 1
  v_max_f32_dpp v18, v18, v18 row_ror:4 row_mask:0xf bank_mask:0xf
  s_nop 1
  v_max_f32_dpp v18, v18, v18 row_ror:2 row_mask:0xf bank_mask:0xf
  s_nop 1
  v_max_f32_dpp v18, v18, v18 row_ror:1 row_mask:0xf bank_mask:0xf
  v_mov_b32 v17, v18
  s_nop 1
  v_permlane16_swap_b32 v18, v17
  v_max_f32 v18, v18, v17
  v_mov_b32 v17, v18
  s_nop 1
  v_permlane32_swap_b32 v18, v17
  v_max_f32 v18, v18, v17
  v_sub_f32 v6, v6, v18
  v_sub_f32 v7, v7, v18
  v_mul_f32 v6, 0x3fb8aa3b, v6
  v_mul_f32 v7, 0x3fb8aa3b, v7
  v_exp_f32 v6, v6
  v_exp_f32 v7, v7
  s_nop 0
  v_add_f32 v19, v6, v7
  s_nop 1
  v_add_f32_dpp v19, v19, v19 row_ror:8 row_mask:0xf bank_mask:0xf
  s_nop 1
  v_add_f32_dpp v19, v19, v19 row_ror:4 row_mask:0xf bank_mask:0xf
  s_nop 1
  v_add_f32_dpp v19, v19, v19 row_ror:2 row_mask:0xf bank_mask:0xf
  s_nop 1
  v_add_f32_dpp v19, v19, v19 row_ror:1 row_mask:0xf bank_mask:0xf
  v_mov_b32 v17, v19
  s_nop 1
  v_permlane16_swap_b32 v19, v17
  v_add_f32 v19, v19, v17
  v_mov_b32 v17, v19
  s_nop 1
  v_permlane32_swap_b32 v19, v17
  v_add_f32 v19, v19, v17
  s_lshl_b32 s14, s3, 3
  v_mov_b32 v17, s14
  s_mov_b64 exec, 1
  ds_write_b64 v17, v[18:19] offset:256
  s_mov_b64 exec, -1
  v_and_b32 v2, 15, v0
  v_lshlrev_b32 v2, 5, v2
  v_lshrrev_b32 v3, 4, v0
  v_lshl_add_u32 v2, v3, 3, v2
  s_lshl_b32 s14, s3, 9
  v_add_u32 v2, s14, v2
  v_lshlrev_b32 v16, 16, v156
  v_and_b32 v17, s12, v156
  v_lshlrev_b32 v18, 16, v157
  v_and_b32 v19, s12, v157
  v_lshlrev_b32 v20, 16, v158
  v_and_b32 v21, s12, v158
  v_lshlrev_b32 v22, 16, v159
  v_and_b32 v23, s12, v159
  v_mul_f32_dpp v8, v6, v16 row_newbcast:0 row_mask:0xf bank_mask:0xf
  v_mul_f32_dpp v9, v6, v17 row_newbcast:0 row_mask:0xf bank_mask:0xf
  v_mul_f32_dpp v10, v6, v18 row_newbcast:0 row_mask:0xf bank_mask:0xf
  v_mul_f32_dpp v11, v6, v19 row_newbcast:0 row_mask:0xf bank_mask:0xf
  v_mul_f32_dpp v12, v6, v20 row_newbcast:0 row_mask:0xf bank_mask:0xf
  v_mul_f32_dpp v13, v6, v21 row_newbcast:0 row_mask:0xf bank_mask:0xf
  v_mul_f32_dpp v14, v6, v22 row_newbcast:0 row_mask:0xf bank_mask:0xf
  v_mul_f32_dpp v15, v6, v23 row_newbcast:0 row_mask:0xf bank_mask:0xf
  v_lshlrev_b32 v16, 16, v160
  v_and_b32 v17, s12, v160
  v_lshlrev_b32 v18, 16, v161
  v_and_b32 v19, s12, v161
  v_lshlrev_b32 v20, 16, v162
  v_and_b32 v21, s12, v162
  v_lshlrev_b32 v22, 16, v163
  v_and_b32 v23, s12, v163
  v_fmac_f32_dpp v8, v6, v16 row_newbcast:8 row_mask:0xf bank_mask:0xf
  v_fmac_f32_dpp v9, v6, v17 row_newbcast:8 row_mask:0xf bank_mask:0xf
  v_fmac_f32_dpp v10, v6, v18 row_newbcast:8 row_mask:0xf bank_mask:0xf
  v_fmac_f32_dpp v11, v6, v19 row_newbcast:8 row_mask:0xf bank_mask:0xf
  v_fmac_f32_dpp v12, v6, v20 row_newbcast:8 row_mask:0xf bank_mask:0xf
  v_fmac_f32_dpp v13, v6, v21 row_newbcast:8 row_mask:0xf bank_mask:0xf
  v_fmac_f32_dpp v14, v6, v22 row_newbcast:8 row_mask:0xf bank_mask:0xf
  v_fmac_f32_dpp v15, v6, v23 row_newbcast:8 row_mask:0xf bank_mask:0xf
  v_lshlrev_b32 v16, 16, v164
  v_and_b32 v17, s12, v164
  v_lshlrev_b32 v18, 16, v165
  v_and_b32 v19, s12, v165
  v_lshlrev_b32 v20, 16, v166
  v_and_b32 v21, s12, v166
  v_lshlrev_b32 v22, 16, v167
  v_and_b32 v23, s12, v167
  v_fmac_f32_dpp v8, v6, v16 row_newbcast:4 row_mask:0xf bank_mask:0xf
  v_fmac_f32_dpp v9, v6, v17 row_newbcast:4 row_mask:0xf bank_mask:0xf
  v_fmac_f32_dpp v10, v6, v18 row_newbcast:4 row_mask:0xf bank_mask:0xf
  v_fmac_f32_dpp v11, v6, v19 row_newbcast:4 row_mask:0xf bank_mask:0xf
  v_fmac_f32_dpp v12, v6, v20 row_newbcast:4 row_mask:0xf bank_mask:0xf
  v_fmac_f32_dpp v13, v6, v21 row_newbcast:4 row_mask:0xf bank_mask:0xf
  v_fmac_f32_dpp v14, v6, v22 row_newbcast:4 row_mask:0xf bank_mask:0xf
  v_fmac_f32_dpp v15, v6, v23 row_newbcast:4 row_mask:0xf bank_mask:0xf
  s_waitcnt vmcnt(4)
  s_waitcnt lgkmcnt(0)
  s_sub_u32 s26, s22, s24
  s_cmp_lt_u32 s26, 1175
  s_cbranch_scc1 L_pcwe40
  s_add_u32 s24, s24, 1
  s_add_u32 s15, s15, 1
L_pce40:
  s_mov_b32 s64, 262144
  buffer_load_dwordx4 v[48:51], v1, s[44:47], s64 offen nt
  s_memrealtime s[22:23]
  v_lshlrev_b32 v16, 16, v28
  v_and_b32 v17, s12, v28
  v_lshlrev_b32 v18, 16, v29
  v_and_b32 v19, s12, v29
  v_lshlrev_b32 v20, 16, v30
  v_and_b32 v21, s12, v30
  v_lshlrev_b32 v22, 16, v31
  v_and_b32 v23, s12, v31
  v_fmac_f32_dpp v8, v6, v16 row_newbcast:12 row_mask:0xf bank_mask:0xf
  v_fmac_f32_dpp v9, v6, v17 row_newbcast:12 row_mask:0xf bank_mask:0xf
  v_fmac_f32_dpp v10, v6, v18 row_newbcast:12 row_mask:0xf bank_mask:0xf
  v_fmac_f32_dpp v11, v6, v19 row_newbcast:12 row_mask:0xf bank_mask:0xf
  v_fmac_f32_dpp v12, v6, v20 row_newbcast:12 row_mask:0xf bank_mask:0xf
  v_fmac_f32_dpp v13, v6, v21 row_newbcast:12 row_mask:0xf bank_mask:0xf
  v_fmac_f32_dpp v14, v6, v22 row_newbcast:12 row_mask:0xf bank_mask:0xf
  v_fmac_f32_dpp v15, v6, v23 row_newbcast:12 row_mask:0xf bank_mask:0xf
  s_waitcnt vmcnt(4)
  s_waitcnt lgkmcnt(0)
  s_sub_u32 s26, s22, s24
  s_cmp_lt_u32 s26, 1201
  s_cbranch_scc1 L_pcwe41
  s_add_u32 s24, s24, 1
  s_add_u32 s15, s15, 1
L_pce41:
  s_mov_b32 s64, 264192
  buffer_load_dwordx4 v[52:55], v1, s[44:47], s64 offen nt
  s_memrealtime s[22:23]
  v_lshlrev_b32 v16, 16, v32
  v_and_b32 v17, s12, v32
  v_lshlrev_b32 v18, 16, v33
  v_and_b32 v19, s12, v33
  v_lshlrev_b32 v20, 16, v34
  v_and_b32 v21, s12, v34
  v_lshlrev_b32 v22, 16, v35
  v_and_b32 v23, s12, v35
  v_fmac_f32_dpp v8, v6, v16 row_newbcast:1 row_mask:0xf bank_mask:0xf
  v_fmac_f32_dpp v9, v6, v17 row_newbcast:1 row_mask:0xf bank_mask:0xf
  v_fmac_f32_dpp v10, v6, v18 row_newbcast:1 row_mask:0xf bank_mask:0xf
  v_fmac_f32_dpp v11, v6, v19 row_newbcast:1 row_mask:0xf bank_mask:0xf
  v_fmac_f32_dpp v12, v6, v20 row_newbcast:1 row_mask:0xf bank_mask:0xf
  v_fmac_f32_dpp v13, v6, v21 row_newbcast:1 row_mask:0xf bank_mask:0xf
  v_fmac_f32_dpp v14, v6, v22 row_newbcast:1 row_mask:0xf bank_mask:0xf
  v_fmac_f32_dpp v15, v6, v23 row_newbcast:1 row_mask:0xf bank_mask:0xf
  s_waitcnt vmcnt(4)
  s_waitcnt lgkmcnt(0)
  s_sub_u32 s26, s22, s24
  s_cmp_lt_u32 s26, 1227
  s_cbranch_scc1 L_pcwe42
  s_add_u32 s24, s24, 1
  s_add_u32 s15, s15, 1
L_pce42:
  s_mov_b32 s64, 262656
  buffer_load_dwordx4 v[56:59], v1, s[44:47], s64 offen nt
  s_memrealtime s[22:23]
  v_lshlrev_b32 v16, 16, v36
  v_and_b32 v17, s12, v36
  v_lshlrev_b32 v18, 16, v37
  v_and_b32 v19, s12, v37
  v_lshlrev_b32 v20, 16, v38
  v_and_b32 v21, s12, v38
  v_lshlrev_b32 v22, 16, v39
  v_and_b32 v23, s12, v39
  v_fmac_f32_dpp v8, v6, v16 row_newbcast:9 row_mask:0xf bank_mask:0xf
  v_fmac_f32_dpp v9, v6, v17 row_newbcast:9 row_mask:0xf bank_mask:0xf
  v_fmac_f32_dpp v10, v6, v18 row_newbcast:9 row_mask:0xf bank_mask:0xf
  v_fmac_f32_dpp v11, v6, v19 row_newbcast:9 row_mask:0xf bank_mask:0xf
  v_fmac_f32_dpp v12, v6, v20 row_newbcast:9 row_mask:0xf bank_mask:0xf
  v_fmac_f32_dpp v13, v6, v21 row_newbcast:9 row_mask:0xf bank_mask:0xf
  v_fmac_f32_dpp v14, v6, v22 row_newbcast:9 row_mask:0xf bank_mask:0xf
  v_fmac_f32_dpp v15, v6, v23 row_newbcast:9 row_mask:0xf bank_mask:0xf
  s_waitcnt vmcnt(4)
  s_waitcnt lgkmcnt(0)
  s_sub_u32 s26, s22, s24
  s_cmp_lt_u32 s26, 1253
  s_cbranch_scc1 L_pcwe43
  s_add_u32 s24, s24, 1
  s_add_u32 s15, s15, 1
L_pce43:
  s_mov_b32 s64, 264704
  buffer_load_dwordx4 v[60:63], v1, s[44:47], s64 offen nt
  s_memrealtime s[22:23]
  v_lshlrev_b32 v16, 16, v40
  v_and_b32 v17, s12, v40
  v_lshlrev_b32 v18, 16, v41
  v_and_b32 v19, s12, v41
  v_lshlrev_b32 v20, 16, v42
  v_and_b32 v21, s12, v42
  v_lshlrev_b32 v22, 16, v43
  v_and_b32 v23, s12, v43
  v_fmac_f32_dpp v8, v6, v16 row_newbcast:5 row_mask:0xf bank_mask:0xf
  v_fmac_f32_dpp v9, v6, v17 row_newbcast:5 row_mask:0xf bank_mask:0xf
  v_fmac_f32_dpp v10, v6, v18 row_newbcast:5 row_mask:0xf bank_mask:0xf
  v_fmac_f32_dpp v11, v6, v19 row_newbcast:5 row_mask:0xf bank_mask:0xf
  v_fmac_f32_dpp v12, v6, v20 row_newbcast:5 row_mask:0xf bank_mask:0xf
  v_fmac_f32_dpp v13, v6, v21 row_newbcast:5 row_mask:0xf bank_mask:0xf
  v_fmac_f32_dpp v14, v6, v22 row_newbcast:5 row_mask:0xf bank_mask:0xf
  v_fmac_f32_dpp v15, v6, v23 row_newbcast:5 row_mask:0xf bank_mask:0xf
  s_waitcnt vmcnt(4)
  s_waitcnt lgkmcnt(0)
  s_sub_u32 s26, s22, s24
  s_cmp_lt_u32 s26, 1279
  s_cbranch_scc1 L_pcwe44
  s_add_u32 s24, s24, 1
  s_add_u32 s15, s15, 1
L_pce44:
  s_mov_b32 s64, 786432
  buffer_load_dwordx4 v[64:67], v1, s[44:47], s64 offen nt
  s_memrealtime s[22:23]
  v_lshlrev_b32 v16, 16, v44
  v_and_b32 v17, s12, v44
  v_lshlrev_b32 v18, 16, v45
  v_and_b32 v19, s12, v45
  v_lshlrev_b32 v20, 16, v46
  v_and_b32 v21, s12, v46
  v_lshlrev_b32 v22, 16, v47
  v_and_b32 v23, s12, v47
  v_fmac_f32_dpp v8, v6, v16 row_newbcast:13 row_mask:0xf bank_mask:0xf
  v_fmac_f32_dpp v9, v6, v17 row_newbcast:13 row_mask:0xf bank_mask:0xf
  v_fmac_f32_dpp v10, v6, v18 row_newbcast:13 row_mask:0xf bank_mask:0xf
  v_fmac_f32_dpp v11, v6, v19 row_newbcast:13 row_mask:0xf bank_mask:0xf
  v_fmac_f32_dpp v12, v6, v20 row_newbcast:13 row_mask:0xf bank_mask:0xf
  v_fmac_f32_dpp v13, v6, v21 row_newbcast:13 row_mask:0xf bank_mask:0xf
  v_fmac_f32_dpp v14, v6, v22 row_newbcast:13 row_mask:0xf bank_mask:0xf
  v_fmac_f32_dpp v15, v6, v23 row_newbcast:13 row_mask:0xf bank_mask:0xf
  s_waitcnt vmcnt(4)
  s_waitcnt lgkmcnt(0)
  s_sub_u32 s26, s22, s24
  s_cmp_lt_u32 s26, 1305
  s_cbranch_scc1 L_pcwe45
  s_add_u32 s24, s24, 1
  s_add_u32 s15, s15, 1
L_pce45:
  s_mov_b32 s64, 788480
  buffer_load_dwordx4 v[68:71], v1, s[44:47], s64 offen nt
  s_memrealtime s[22:23]
  v_lshlrev_b32 v16, 16, v48
  v_and_b32 v17, s12, v48
  v_lshlrev_b32 v18, 16, v49
  v_and_b32 v19, s12, v49
  v_lshlrev_b32 v20, 16, v50
  v_and_b32 v21, s12, v50
  v_lshlrev_b32 v22, 16, v51
  v_and_b32 v23, s12, v51
  v_fmac_f32_dpp v8, v6, v16 row_newbcast:2 row_mask:0xf bank_mask:0xf
  v_fmac_f32_dpp v9, v6, v17 row_newbcast:2 row_mask:0xf bank_mask:0xf
  v_fmac_f32_dpp v10, v6, v18 row_newbcast:2 row_mask:0xf bank_mask:0xf
  v_fmac_f32_dpp v11, v6, v19 row_newbcast:2 row_mask:0xf bank_mask:0xf
  v_fmac_f32_dpp v12, v6, v20 row_newbcast:2 row_mask:0xf bank_mask:0xf
  v_fmac_f32_dpp v13, v6, v21 row_newbcast:2 row_mask:0xf bank_mask:0xf
  v_fmac_f32_dpp v14, v6, v22 row_newbcast:2 row_mask:0xf bank_mask:0xf
  v_fmac_f32_dpp v15, v6, v23 row_newbcast:2 row_mask:0xf bank_mask:0xf
  s_waitcnt vmcnt(4)
  s_waitcnt lgkmcnt(0)
  s_sub_u32 s26, s22, s24
  s_cmp_lt_u32 s26, 1331
  s_cbranch_scc1 L_pcwe46
  s_add_u32 s24, s24, 1
  s_add_u32 s15, s15, 1
L_pce46:
  s_mov_b32 s64, 786944
  buffer_load_dwordx4 v[72:75], v1, s[44:47], s64 offen nt
  s_memrealtime s[22:23]
  v_lshlrev_b32 v16, 16, v52
  v_and_b32 v17, s12, v52
  v_lshlrev_b32 v18, 16, v53
  v_and_b32 v19, s12, v53
  v_lshlrev_b32 v20, 16, v54
  v_and_b32 v21, s12, v54
  v_lshlrev_b32 v22, 16, v55
  v_and_b32 v23, s12, v55
  v_fmac_f32_dpp v8, v6, v16 row_newbcast:10 row_mask:0xf bank_mask:0xf
  v_fmac_f32_dpp v9, v6, v17 row_newbcast:10 row_mask:0xf bank_mask:0xf
  v_fmac_f32_dpp v10, v6, v18 row_newbcast:10 row_mask:0xf bank_mask:0xf
  v_fmac_f32_dpp v11, v6, v19 row_newbcast:10 row_mask:0xf bank_mask:0xf
  v_fmac_f32_dpp v12, v6, v20 row_newbcast:10 row_mask:0xf bank_mask:0xf
  v_fmac_f32_dpp v13, v6, v21 row_newbcast:10 row_mask:0xf bank_mask:0xf
  v_fmac_f32_dpp v14, v6, v22 row_newbcast:10 row_mask:0xf bank_mask:0xf
  v_fmac_f32_dpp v15, v6, v23 row_newbcast:10 row_mask:0xf bank_mask:0xf
  s_waitcnt vmcnt(4)
  s_waitcnt lgkmcnt(0)
  s_sub_u32 s26, s22, s24
  s_cmp_lt_u32 s26, 1357
  s_cbranch_scc1 L_pcwe47
  s_add_u32 s24, s24, 1
  s_add_u32 s15, s15, 1
L_pce47:
  s_mov_b32 s64, 788992
  buffer_load_dwordx4 v[76:79], v1, s[44:47], s64 offen nt
  s_memrealtime s[22:23]
  v_lshlrev_b32 v16, 16, v56
  v_and_b32 v17, s12, v56
  v_lshlrev_b32 v18, 16, v57
  v_and_b32 v19, s12, v57
  v_lshlrev_b32 v20, 16, v58
  v_and_b32 v21, s12, v58
  v_lshlrev_b32 v22, 16, v59
  v_and_b32 v23, s12, v59
  v_fmac_f32_dpp v8, v6, v16 row_newbcast:6 row_mask:0xf bank_mask:0xf
  v_fmac_f32_dpp v9, v6, v17 row_newbcast:6 row_mask:0xf bank_mask:0xf
  v_fmac_f32_dpp v10, v6, v18 row_newbcast:6 row_mask:0xf bank_mask:0xf
  v_fmac_f32_dpp v11, v6, v19 row_newbcast:6 row_mask:0xf bank_mask:0xf
  v_fmac_f32_dpp v12, v6, v20 row_newbcast:6 row_mask:0xf bank_mask:0xf
  v_fmac_f32_dpp v13, v6, v21 row_newbcast:6 row_mask:0xf bank_mask:0xf
  v_fmac_f32_dpp v14, v6, v22 row_newbcast:6 row_mask:0xf bank_mask:0xf
  v_fmac_f32_dpp v15, v6, v23 row_newbcast:6 row_mask:0xf bank_mask:0xf
  s_waitcnt vmcnt(4)
  s_waitcnt lgkmcnt(0)
  s_sub_u32 s26, s22, s24
  s_cmp_lt_u32 s26, 1383
  s_cbranch_scc1 L_pcwe48
  s_add_u32 s24, s24, 1
  s_add_u32 s15, s15, 1
L_pce48:
  s_mov_b32 s64, 131072
  buffer_load_dwordx4 v[80:83], v1, s[44:47], s64 offen nt
  s_memrealtime s[22:23]
  v_lshlrev_b32 v16, 16, v60
  v_and_b32 v17, s12, v60
  v_lshlrev_b32 v18, 16, v61
  v_and_b32 v19, s12, v61
  v_lshlrev_b32 v20, 16, v62
  v_and_b32 v21, s12, v62
  v_lshlrev_b32 v22, 16, v63
  v_and_b32 v23, s12, v63
  v_fmac_f32_dpp v8, v6, v16 row_newbcast:14 row_mask:0xf bank_mask:0xf
  v_fmac_f32_dpp v9, v6, v17 row_newbcast:14 row_mask:0xf bank_mask:0xf
  v_fmac_f32_dpp v10, v6, v18 row_newbcast:14 row_mask:0xf bank_mask:0xf
  v_fmac_f32_dpp v11, v6, v19 row_newbcast:14 row_mask:0xf bank_mask:0xf
  v_fmac_f32_dpp v12, v6, v20 row_newbcast:14 row_mask:0xf bank_mask:0xf
  v_fmac_f32_dpp v13, v6, v21 row_newbcast:14 row_mask:0xf bank_mask:0xf
  v_fmac_f32_dpp v14, v6, v22 row_newbcast:14 row_mask:0xf bank_mask:0xf
  v_fmac_f32_dpp v15, v6, v23 row_newbcast:14 row_mask:0xf bank_mask:0xf
  s_waitcnt vmcnt(4)
  s_waitcnt lgkmcnt(0)
  s_sub_u32 s26, s22, s24
  s_cmp_lt_u32 s26, 1409
  s_cbranch_scc1 L_pcwe49
  s_add_u32 s24, s24, 1
  s_add_u32 s15, s15, 1
L_pce49:
  s_mov_b32 s64, 133120
  buffer_load_dwordx4 v[84:87], v1, s[44:47], s64 offen nt
  s_memrealtime s[22:23]
  v_lshlrev_b32 v16, 16, v64
  v_and_b32 v17, s12, v64
  v_lshlrev_b32 v18, 16, v65
  v_and_b32 v19, s12, v65
  v_lshlrev_b32 v20, 16, v66
  v_and_b32 v21, s12, v66
  v_lshlrev_b32 v22, 16, v67
  v_and_b32 v23, s12, v67
  v_fmac_f32_dpp v8, v6, v16 row_newbcast:3 row_mask:0xf bank_mask:0xf
  v_fmac_f32_dpp v9, v6, v17 row_newbcast:3 row_mask:0xf bank_mask:0xf
  v_fmac_f32_dpp v10, v6, v18 row_newbcast:3 row_mask:0xf bank_mask:0xf
  v_fmac_f32_dpp v11, v6, v19 row_newbcast:3 row_mask:0xf bank_mask:0xf
  v_fmac_f32_dpp v12, v6, v20 row_newbcast:3 row_mask:0xf bank_mask:0xf
  v_fmac_f32_dpp v13, v6, v21 row_newbcast:3 row_mask:0xf bank_mask:0xf
  v_fmac_f32_dpp v14, v6, v22 row_newbcast:3 row_mask:0xf bank_mask:0xf
  v_fmac_f32_dpp v15, v6, v23 row_newbcast:3 row_mask:0xf bank_mask:0xf
  s_waitcnt vmcnt(4)
  s_waitcnt lgkmcnt(0)
  s_sub_u32 s26, s22, s24
  s_cmp_lt_u32 s26, 1435
  s_cbranch_scc1 L_pcwe50
  s_add_u32 s24, s24, 1
  s_add_u32 s15, s15, 1
L_pce50:
  s_mov_b32 s64, 131584
  buffer_load_dwordx4 v[88:91], v1, s[44:47], s64 offen nt
  s_memrealtime s[22:23]
  v_lshlrev_b32 v16, 16, v68
  v_and_b32 v17, s12, v68
  v_lshlrev_b32 v18, 16, v69
  v_and_b32 v19, s12, v69
  v_lshlrev_b32 v20, 16, v70
  v_and_b32 v21, s12, v70
  v_lshlrev_b32 v22, 16, v71
  v_and_b32 v23, s12, v71
  v_fmac_f32_dpp v8, v6, v16 row_newbcast:11 row_mask:0xf bank_mask:0xf
  v_fmac_f32_dpp v9, v6, v17 row_newbcast:11 row_mask:0xf bank_mask:0xf
  v_fmac_f32_dpp v10, v6, v18 row_newbcast:11 row_mask:0xf bank_mask:0xf
  v_fmac_f32_dpp v11, v6, v19 row_newbcast:11 row_mask:0xf bank_mask:0xf
  v_fmac_f32_dpp v12, v6, v20 row_newbcast:11 row_mask:0xf bank_mask:0xf
  v_fmac_f32_dpp v13, v6, v21 row_newbcast:11 row_mask:0xf bank_mask:0xf
  v_fmac_f32_dpp v14, v6, v22 row_newbcast:11 row_mask:0xf bank_mask:0xf
  v_fmac_f32_dpp v15, v6, v23 row_newbcast:11 row_mask:0xf bank_mask:0xf
  s_waitcnt vmcnt(4)
  s_waitcnt lgkmcnt(0)
  s_sub_u32 s26, s22, s24
  s_cmp_lt_u32 s26, 1461
  s_cbranch_scc1 L_pcwe51
  s_add_u32 s24, s24, 1
  s_add_u32 s15, s15, 1
L_pce51:
  s_mov_b32 s64, 133632
  buffer_load_dwordx4 v[92:95], v1, s[44:47], s64 offen nt
  s_memrealtime s[22:23]
  v_lshlrev_b32 v16, 16, v72
  v_and_b32 v17, s12, v72
  v_lshlrev_b32 v18, 16, v73
  v_and_b32 v19, s12, v73
  v_lshlrev_b32 v20, 16, v74
  v_and_b32 v21, s12, v74
  v_lshlrev_b32 v22, 16, v75
  v_and_b32 v23, s12, v75
  v_fmac_f32_dpp v8, v6, v16 row_newbcast:7 row_mask:0xf bank_mask:0xf
  v_fmac_f32_dpp v9, v6, v17 row_newbcast:7 row_mask:0xf bank_mask:0xf
  v_fmac_f32_dpp v10, v6, v18 row_newbcast:7 row_mask:0xf bank_mask:0xf
  v_fmac_f32_dpp v11, v6, v19 row_newbcast:7 row_mask:0xf bank_mask:0xf
  v_fmac_f32_dpp v12, v6, v20 row_newbcast:7 row_mask:0xf bank_mask:0xf
  v_fmac_f32_dpp v13, v6, v21 row_newbcast:7 row_mask:0xf bank_mask:0xf
  v_fmac_f32_dpp v14, v6, v22 row_newbcast:7 row_mask:0xf bank_mask:0xf
  v_fmac_f32_dpp v15, v6, v23 row_newbcast:7 row_mask:0xf bank_mask:0xf
  s_waitcnt vmcnt(4)
  s_waitcnt lgkmcnt(0)
  s_sub_u32 s26, s22, s24
  s_cmp_lt_u32 s26, 1486
  s_cbranch_scc1 L_pcwe52
  s_add_u32 s24, s24, 1
  s_add_u32 s15, s15, 1
L_pce52:
  s_mov_b32 s64, 655360
  buffer_load_dwordx4 v[96:99], v1, s[44:47], s64 offen nt
  s_memrealtime s[22:23]
  v_lshlrev_b32 v16, 16, v76
  v_and_b32 v17, s12, v76
  v_lshlrev_b32 v18, 16, v77
  v_and_b32 v19, s12, v77
  v_lshlrev_b32 v20, 16, v78
  v_and_b32 v21, s12, v78
  v_lshlrev_b32 v22, 16, v79
  v_and_b32 v23, s12, v79
  v_fmac_f32_dpp v8, v6, v16 row_newbcast:15 row_mask:0xf bank_mask:0xf
  v_fmac_f32_dpp v9, v6, v17 row_newbcast:15 row_mask:0xf bank_mask:0xf
  v_fmac_f32_dpp v10, v6, v18 row_newbcast:15 row_mask:0xf bank_mask:0xf
  v_fmac_f32_dpp v11, v6, v19 row_newbcast:15 row_mask:0xf bank_mask:0xf
  v_fmac_f32_dpp v12, v6, v20 row_newbcast:15 row_mask:0xf bank_mask:0xf
  v_fmac_f32_dpp v13, v6, v21 row_newbcast:15 row_mask:0xf bank_mask:0xf
  v_fmac_f32_dpp v14, v6, v22 row_newbcast:15 row_mask:0xf bank_mask:0xf
  v_fmac_f32_dpp v15, v6, v23 row_newbcast:15 row_mask:0xf bank_mask:0xf
  s_waitcnt vmcnt(4)
  s_waitcnt lgkmcnt(0)
  s_sub_u32 s26, s22, s24
  s_cmp_lt_u32 s26, 1512
  s_cbranch_scc1 L_pcwe53
  s_add_u32 s24, s24, 1
  s_add_u32 s15, s15, 1
L_pce53:
  s_mov_b32 s64, 657408
  buffer_load_dwordx4 v[100:103], v1, s[44:47], s64 offen nt
  s_memrealtime s[22:23]
  v_lshlrev_b32 v16, 16, v80
  v_and_b32 v17, s12, v80
  v_lshlrev_b32 v18, 16, v81
  v_and_b32 v19, s12, v81
  v_lshlrev_b32 v20, 16, v82
  v_and_b32 v21, s12, v82
  v_lshlrev_b32 v22, 16, v83
  v_and_b32 v23, s12, v83
  v_fmac_f32_dpp v8, v7, v16 row_newbcast:0 row_mask:0xf bank_mask:0xf
  v_fmac_f32_dpp v9, v7, v17 row_newbcast:0 row_mask:0xf bank_mask:0xf
  v_fmac_f32_dpp v10, v7, v18 row_newbcast:0 row_mask:0xf bank_mask:0xf
  v_fmac_f32_dpp v11, v7, v19 row_newbcast:0 row_mask:0xf bank_mask:0xf
  v_fmac_f32_dpp v12, v7, v20 row_newbcast:0 row_mask:0xf bank_mask:0xf
  v_fmac_f32_dpp v13, v7, v21 row_newbcast:0 row_mask:0xf bank_mask:0xf
  v_fmac_f32_dpp v14, v7, v22 row_newbcast:0 row_mask:0xf bank_mask:0xf
  v_fmac_f32_dpp v15, v7, v23 row_newbcast:0 row_mask:0xf bank_mask:0xf
  s_waitcnt vmcnt(4)
  s_waitcnt lgkmcnt(0)
  s_sub_u32 s26, s22, s24
  s_cmp_lt_u32 s26, 1538
  s_cbranch_scc1 L_pcwe54
  s_add_u32 s24, s24, 1
  s_add_u32 s15, s15, 1
L_pce54:
  s_mov_b32 s64, 655872
  buffer_load_dwordx4 v[104:107], v1, s[44:47], s64 offen nt
  s_memrealtime s[22:23]
  v_lshlrev_b32 v16, 16, v84
  v_and_b32 v17, s12, v84
  v_lshlrev_b32 v18, 16, v85
  v_and_b32 v19, s12, v85
  v_lshlrev_b32 v20, 16, v86
  v_and_b32 v21, s12, v86
  v_lshlrev_b32 v22, 16, v87
  v_and_b32 v23, s12, v87
  v_fmac_f32_dpp v8, v7, v16 row_newbcast:8 row_mask:0xf bank_mask:0xf
  v_fmac_f32_dpp v9, v7, v17 row_newbcast:8 row_mask:0xf bank_mask:0xf
  v_fmac_f32_dpp v10, v7, v18 row_newbcast:8 row_mask:0xf bank_mask:0xf
  v_fmac_f32_dpp v11, v7, v19 row_newbcast:8 row_mask:0xf bank_mask:0xf
  v_fmac_f32_dpp v12, v7, v20 row_newbcast:8 row_mask:0xf bank_mask:0xf
  v_fmac_f32_dpp v13, v7, v21 row_newbcast:8 row_mask:0xf bank_mask:0xf
  v_fmac_f32_dpp v14, v7, v22 row_newbcast:8 row_mask:0xf bank_mask:0xf
  v_fmac_f32_dpp v15, v7, v23 row_newbcast:8 row_mask:0xf bank_mask:0xf
  s_waitcnt vmcnt(4)
  s_waitcnt lgkmcnt(0)
  s_sub_u32 s26, s22, s24
  s_cmp_lt_u32 s26, 1564
  s_cbranch_scc1 L_pcwe55
  s_add_u32 s24, s24, 1
  s_add_u32 s15, s15, 1
L_pce55:
  s_mov_b32 s64, 657920
  buffer_load_dwordx4 v[108:111], v1, s[44:47], s64 offen nt
  s_memrealtime s[22:23]
  v_lshlrev_b32 v16, 16, v88
  v_and_b32 v17, s12, v88
  v_lshlrev_b32 v18, 16, v89
  v_and_b32 v19, s12, v89
  v_lshlrev_b32 v20, 16, v90
  v_and_b32 v21, s12, v90
  v_lshlrev_b32 v22, 16, v91
  v_and_b32 v23, s12, v91
  v_fmac_f32_dpp v8, v7, v16 row_newbcast:4 row_mask:0xf bank_mask:0xf
  v_fmac_f32_dpp v9, v7, v17 row_newbcast:4 row_mask:0xf bank_mask:0xf
  v_fmac_f32_dpp v10, v7, v18 row_newbcast:4 row_mask:0xf bank_mask:0xf
  v_fmac_f32_dpp v11, v7, v19 row_newbcast:4 row_mask:0xf bank_mask:0xf
  v_fmac_f32_dpp v12, v7, v20 row_newbcast:4 row_mask:0xf bank_mask:0xf
  v_fmac_f32_dpp v13, v7, v21 row_newbcast:4 row_mask:0xf bank_mask:0xf
  v_fmac_f32_dpp v14, v7, v22 row_newbcast:4 row_mask:0xf bank_mask:0xf
  v_fmac_f32_dpp v15, v7, v23 row_newbcast:4 row_mask:0xf bank_mask:0xf
  s_waitcnt vmcnt(4)
  s_waitcnt lgkmcnt(0)
  s_sub_u32 s26, s22, s24
  s_cmp_lt_u32 s26, 1590
  s_cbranch_scc1 L_pcwe56
  s_add_u32 s24, s24, 1
  s_add_u32 s15, s15, 1
L_pce56:
  s_mov_b32 s64, 393216
  buffer_load_dwordx4 v[112:115], v1, s[44:47], s64 offen nt
  s_memrealtime s[22:23]
  v_lshlrev_b32 v16, 16, v92
  v_and_b32 v17, s12, v92
  v_lshlrev_b32 v18, 16, v93
  v_and_b32 v19, s12, v93
  v_lshlrev_b32 v20, 16, v94
  v_and_b32 v21, s12, v94
  v_lshlrev_b32 v22, 16, v95
  v_and_b32 v23, s12, v95
  v_fmac_f32_dpp v8, v7, v16 row_newbcast:12 row_mask:0xf bank_mask:0xf
  v_fmac_f32_dpp v9, v7, v17 row_newbcast:12 row_mask:0xf bank_mask:0xf
  v_fmac_f32_dpp v10, v7, v18 row_newbcast:12 row_mask:0xf bank_mask:0xf
  v_fmac_f32_dpp v11, v7, v19 row_newbcast:12 row_mask:0xf bank_mask:0xf
  v_fmac_f32_dpp v12, v7, v20 row_newbcast:12 row_mask:0xf bank_mask:0xf
  v_fmac_f32_dpp v13, v7, v21 row_newbcast:12 row_mask:0xf bank_mask:0xf
  v_fmac_f32_dpp v14, v7, v22 row_newbcast:12 row_mask:0xf bank_mask:0xf
  v_fmac_f32_dpp v15, v7, v23 row_newbcast:12 row_mask:0xf bank_mask:0xf
  s_waitcnt vmcnt(4)
  s_waitcnt lgkmcnt(0)
  s_sub_u32 s26, s22, s24
  s_cmp_lt_u32 s26, 1616
  s_cbranch_scc1 L_pcwe57
  s_add_u32 s24, s24, 1
  s_add_u32 s15, s15, 1
L_pce57:
  s_mov_b32 s64, 395264
  buffer_load_dwordx4 v[116:119], v1, s[44:47], s64 offen nt
  s_memrealtime s[22:23]
  v_lshlrev_b32 v16, 16, v96
  v_and_b32 v17, s12, v96
  v_lshlrev_b32 v18, 16, v97
  v_and_b32 v19, s12, v97
  v_lshlrev_b32 v20, 16, v98
  v_and_b32 v21, s12, v98
  v_lshlrev_b32 v22, 16, v99
  v_and_b32 v23, s12, v99
  v_fmac_f32_dpp v8, v7, v16 row_newbcast:1 row_mask:0xf bank_mask:0xf
  v_fmac_f32_dpp v9, v7, v17 row_newbcast:1 row_mask:0xf bank_mask:0xf
  v_fmac_f32_dpp v10, v7, v18 row_newbcast:1 row_mask:0xf bank_mask:0xf
  v_fmac_f32_dpp v11, v7, v19 row_newbcast:1 row_mask:0xf bank_mask:0xf
  v_fmac_f32_dpp v12, v7, v20 row_newbcast:1 row_mask:0xf bank_mask:0xf
  v_fmac_f32_dpp v13, v7, v21 row_newbcast:1 row_mask:0xf bank_mask:0xf
  v_fmac_f32_dpp v14, v7, v22 row_newbcast:1 row_mask:0xf bank_mask:0xf
  v_fmac_f32_dpp v15, v7, v23 row_newbcast:1 row_mask:0xf bank_mask:0xf
  s_waitcnt vmcnt(4)
  s_waitcnt lgkmcnt(0)
  s_sub_u32 s26, s22, s24
  s_cmp_lt_u32 s26, 1642
  s_cbranch_scc1 L_pcwe58
  s_add_u32 s24, s24, 1
  s_add_u32 s15, s15, 1
L_pce58:
  s_mov_b32 s64, 393728
  buffer_load_dwordx4 v[120:123], v1, s[44:47], s64 offen nt
  s_memrealtime s[22:23]
  v_lshlrev_b32 v16, 16, v100
  v_and_b32 v17, s12, v100
  v_lshlrev_b32 v18, 16, v101
  v_and_b32 v19, s12, v101
  v_lshlrev_b32 v20, 16, v102
  v_and_b32 v21, s12, v102
  v_lshlrev_b32 v22, 16, v103
  v_and_b32 v23, s12, v103
  v_fmac_f32_dpp v8, v7, v16 row_newbcast:9 row_mask:0xf bank_mask:0xf
  v_fmac_f32_dpp v9, v7, v17 row_newbcast:9 row_mask:0xf bank_mask:0xf
  v_fmac_f32_dpp v10, v7, v18 row_newbcast:9 row_mask:0xf bank_mask:0xf
  v_fmac_f32_dpp v11, v7, v19 row_newbcast:9 row_mask:0xf bank_mask:0xf
  v_fmac_f32_dpp v12, v7, v20 row_newbcast:9 row_mask:0xf bank_mask:0xf
  v_fmac_f32_dpp v13, v7, v21 row_newbcast:9 row_mask:0xf bank_mask:0xf
  v_fmac_f32_dpp v14, v7, v22 row_newbcast:9 row_mask:0xf bank_mask:0xf
  v_fmac_f32_dpp v15, v7, v23 row_newbcast:9 row_mask:0xf bank_mask:0xf
  s_waitcnt vmcnt(4)
  s_waitcnt lgkmcnt(0)
  s_sub_u32 s26, s22, s24
  s_cmp_lt_u32 s26, 1668
  s_cbranch_scc1 L_pcwe59
  s_add_u32 s24, s24, 1
  s_add_u32 s15, s15, 1
L_pce59:
  s_mov_b32 s64, 395776
  buffer_load_dwordx4 v[124:127], v1, s[44:47], s64 offen nt
  s_memrealtime s[22:23]
  v_lshlrev_b32 v16, 16, v104
  v_and_b32 v17, s12, v104
  v_lshlrev_b32 v18, 16, v105
  v_and_b32 v19, s12, v105
  v_lshlrev_b32 v20, 16, v106
  v_and_b32 v21, s12, v106
  v_lshlrev_b32 v22, 16, v107
  v_and_b32 v23, s12, v107
  v_fmac_f32_dpp v8, v7, v16 row_newbcast:5 row_mask:0xf bank_mask:0xf
  v_fmac_f32_dpp v9, v7, v17 row_newbcast:5 row_mask:0xf bank_mask:0xf
  v_fmac_f32_dpp v10, v7, v18 row_newbcast:5 row_mask:0xf bank_mask:0xf
  v_fmac_f32_dpp v11, v7, v19 row_newbcast:5 row_mask:0xf bank_mask:0xf
  v_fmac_f32_dpp v12, v7, v20 row_newbcast:5 row_mask:0xf bank_mask:0xf
  v_fmac_f32_dpp v13, v7, v21 row_newbcast:5 row_mask:0xf bank_mask:0xf
  v_fmac_f32_dpp v14, v7, v22 row_newbcast:5 row_mask:0xf bank_mask:0xf
  v_fmac_f32_dpp v15, v7, v23 row_newbcast:5 row_mask:0xf bank_mask:0xf
  s_waitcnt vmcnt(4)
  s_waitcnt lgkmcnt(0)
  s_sub_u32 s26, s22, s24
  s_cmp_lt_u32 s26, 1694
  s_cbranch_scc1 L_pcwe60
  s_add_u32 s24, s24, 1
  s_add_u32 s15, s15, 1
L_pce60:
  s_mov_b32 s64, 917504
  buffer_load_dwordx4 v[128:131], v1, s[44:47], s64 offen nt
  s_memrealtime s[22:23]
  v_lshlrev_b32 v16, 16, v108
  v_and_b32 v17, s12, v108
  v_lshlrev_b32 v18, 16, v109
  v_and_b32 v19, s12, v109
  v_lshlrev_b32 v20, 16, v110
  v_and_b32 v21, s12, v110
  v_lshlrev_b32 v22, 16, v111
  v_and_b32 v23, s12, v111
  v_fmac_f32_dpp v8, v7, v16 row_newbcast:13 row_mask:0xf bank_mask:0xf
  v_fmac_f32_dpp v9, v7, v17 row_newbcast:13 row_mask:0xf bank_mask:0xf
  v_fmac_f32_dpp v10, v7, v18 row_newbcast:13 row_mask:0xf bank_mask:0xf
  v_fmac_f32_dpp v11, v7, v19 row_newbcast:13 row_mask:0xf bank_mask:0xf
  v_fmac_f32_dpp v12, v7, v20 row_newbcast:13 row_mask:0xf bank_mask:0xf
  v_fmac_f32_dpp v13, v7, v21 row_newbcast:13 row_mask:0xf bank_mask:0xf
  v_fmac_f32_dpp v14, v7, v22 row_newbcast:13 row_mask:0xf bank_mask:0xf
  v_fmac_f32_dpp v15, v7, v23 row_newbcast:13 row_mask:0xf bank_mask:0xf
  s_waitcnt vmcnt(4)
  s_waitcnt lgkmcnt(0)
  s_sub_u32 s26, s22, s24
  s_cmp_lt_u32 s26, 1720
  s_cbranch_scc1 L_pcwe61
  s_add_u32 s24, s24, 1
  s_add_u32 s15, s15, 1
L_pce61:
  s_mov_b32 s64, 919552
  buffer_load_dwordx4 v[132:135], v1, s[44:47], s64 offen nt
  s_memrealtime s[22:23]
  v_lshlrev_b32 v16, 16, v112
  v_and_b32 v17, s12, v112
  v_lshlrev_b32 v18, 16, v113
  v_and_b32 v19, s12, v113
  v_lshlrev_b32 v20, 16, v114
  v_and_b32 v21, s12, v114
  v_lshlrev_b32 v22, 16, v115
  v_and_b32 v23, s12, v115
  v_fmac_f32_dpp v8, v7, v16 row_newbcast:2 row_mask:0xf bank_mask:0xf
  v_fmac_f32_dpp v9, v7, v17 row_newbcast:2 row_mask:0xf bank_mask:0xf
  v_fmac_f32_dpp v10, v7, v18 row_newbcast:2 row_mask:0xf bank_mask:0xf
  v_fmac_f32_dpp v11, v7, v19 row_newbcast:2 row_mask:0xf bank_mask:0xf
  v_fmac_f32_dpp v12, v7, v20 row_newbcast:2 row_mask:0xf bank_mask:0xf
  v_fmac_f32_dpp v13, v7, v21 row_newbcast:2 row_mask:0xf bank_mask:0xf
  v_fmac_f32_dpp v14, v7, v22 row_newbcast:2 row_mask:0xf bank_mask:0xf
  v_fmac_f32_dpp v15, v7, v23 row_newbcast:2 row_mask:0xf bank_mask:0xf
  s_waitcnt vmcnt(4)
  s_waitcnt lgkmcnt(0)
  s_sub_u32 s26, s22, s24
  s_cmp_lt_u32 s26, 1746
  s_cbranch_scc1 L_pcwe62
  s_add_u32 s24, s24, 1
  s_add_u32 s15, s15, 1
L_pce62:
  s_mov_b32 s64, 918016
  buffer_load_dwordx4 v[136:139], v1, s[44:47], s64 offen nt
  s_memrealtime s[22:23]
  v_lshlrev_b32 v16, 16, v116
  v_and_b32 v17, s12, v116
  v_lshlrev_b32 v18, 16, v117
  v_and_b32 v19, s12, v117
  v_lshlrev_b32 v20, 16, v118
  v_and_b32 v21, s12, v118
  v_lshlrev_b32 v22, 16, v119
  v_and_b32 v23, s12, v119
  v_fmac_f32_dpp v8, v7, v16 row_newbcast:10 row_mask:0xf bank_mask:0xf
  v_fmac_f32_dpp v9, v7, v17 row_newbcast:10 row_mask:0xf bank_mask:0xf
  v_fmac_f32_dpp v10, v7, v18 row_newbcast:10 row_mask:0xf bank_mask:0xf
  v_fmac_f32_dpp v11, v7, v19 row_newbcast:10 row_mask:0xf bank_mask:0xf
  v_fmac_f32_dpp v12, v7, v20 row_newbcast:10 row_mask:0xf bank_mask:0xf
  v_fmac_f32_dpp v13, v7, v21 row_newbcast:10 row_mask:0xf bank_mask:0xf
  v_fmac_f32_dpp v14, v7, v22 row_newbcast:10 row_mask:0xf bank_mask:0xf
  v_fmac_f32_dpp v15, v7, v23 row_newbcast:10 row_mask:0xf bank_mask:0xf
  s_waitcnt vmcnt(4)
  s_waitcnt lgkmcnt(0)
  s_sub_u32 s26, s22, s24
  s_cmp_lt_u32 s26, 1772
  s_cbranch_scc1 L_pcwe63
  s_add_u32 s24, s24, 1
  s_add_u32 s15, s15, 1
L_pce63:
  s_mov_b32 s64, 920064
  buffer_load_dwordx4 v[140:143], v1, s[44:47], s64 offen nt
  v_lshlrev_b32 v16, 16, v120
  v_and_b32 v17, s12, v120
  v_lshlrev_b32 v18, 16, v121
  v_and_b32 v19, s12, v121
  v_lshlrev_b32 v20, 16, v122
  v_and_b32 v21, s12, v122
  v_lshlrev_b32 v22, 16, v123
  v_and_b32 v23, s12, v123
  v_fmac_f32_dpp v8, v7, v16 row_newbcast:6 row_mask:0xf bank_mask:0xf
  v_fmac_f32_dpp v9, v7, v17 row_newbcast:6 row_mask:0xf bank_mask:0xf
  v_fmac_f32_dpp v10, v7, v18 row_newbcast:6 row_mask:0xf bank_mask:0xf
  v_fmac_f32_dpp v11, v7, v19 row_newbcast:6 row_mask:0xf bank_mask:0xf
  v_fmac_f32_dpp v12, v7, v20 row_newbcast:6 row_mask:0xf bank_mask:0xf
  v_fmac_f32_dpp v13, v7, v21 row_newbcast:6 row_mask:0xf bank_mask:0xf
  v_fmac_f32_dpp v14, v7, v22 row_newbcast:6 row_mask:0xf bank_mask:0xf
  v_fmac_f32_dpp v15, v7, v23 row_newbcast:6 row_mask:0xf bank_mask:0xf
  s_waitcnt vmcnt(4)
  v_lshlrev_b32 v16, 16, v124
  v_and_b32 v17, s12, v124
  v_lshlrev_b32 v18, 16, v125
  v_and_b32 v19, s12, v125
  v_lshlrev_b32 v20, 16, v126
  v_and_b32 v21, s12, v126
  v_lshlrev_b32 v22, 16, v127
  v_and_b32 v23, s12, v127
  v_fmac_f32_dpp v8, v7, v16 row_newbcast:14 row_mask:0xf bank_mask:0xf
  v_fmac_f32_dpp v9, v7, v17 row_newbcast:14 row_mask:0xf bank_mask:0xf
  v_fmac_f32_dpp v10, v7, v18 row_newbcast:14 row_mask:0xf bank_mask:0xf
  v_fmac_f32_dpp v11, v7, v19 row_newbcast:14 row_mask:0xf bank_mask:0xf
  v_fmac_f32_dpp v12, v7, v20 row_newbcast:14 row_mask:0xf bank_mask:0xf
  v_fmac_f32_dpp v13, v7, v21 row_newbcast:14 row_mask:0xf bank_mask:0xf
  v_fmac_f32_dpp v14, v7, v22 row_newbcast:14 row_mask:0xf bank_mask:0xf
  v_fmac_f32_dpp v15, v7, v23 row_newbcast:14 row_mask:0xf bank_mask:0xf
  s_waitcnt vmcnt(3)
  v_lshlrev_b32 v16, 16, v128
  v_and_b32 v17, s12, v128
  v_lshlrev_b32 v18, 16, v129
  v_and_b32 v19, s12, v129
  v_lshlrev_b32 v20, 16, v130
  v_and_b32 v21, s12, v130
  v_lshlrev_b32 v22, 16, v131
  v_and_b32 v23, s12, v131
  v_fmac_f32_dpp v8, v7, v16 row_newbcast:3 row_mask:0xf bank_mask:0xf
  v_fmac_f32_dpp v9, v7, v17 row_newbcast:3 row_mask:0xf bank_mask:0xf
  v_fmac_f32_dpp v10, v7, v18 row_newbcast:3 row_mask:0xf bank_mask:0xf
  v_fmac_f32_dpp v11, v7, v19 row_newbcast:3 row_mask:0xf bank_mask:0xf
  v_fmac_f32_dpp v12, v7, v20 row_newbcast:3 row_mask:0xf bank_mask:0xf
  v_fmac_f32_dpp v13, v7, v21 row_newbcast:3 row_mask:0xf bank_mask:0xf
  v_fmac_f32_dpp v14, v7, v22 row_newbcast:3 row_mask:0xf bank_mask:0xf
  v_fmac_f32_dpp v15, v7, v23 row_newbcast:3 row_mask:0xf bank_mask:0xf
  s_waitcnt vmcnt(2)
  s_barrier
  v_lshlrev_b32 v16, 16, v132
  v_and_b32 v17, s12, v132
  v_lshlrev_b32 v18, 16, v133
  v_and_b32 v19, s12, v133
  v_lshlrev_b32 v20, 16, v134
  v_and_b32 v21, s12, v134
  v_lshlrev_b32 v22, 16, v135
  v_and_b32 v23, s12, v135
  v_fmac_f32_dpp v8, v7, v16 row_newbcast:11 row_mask:0xf bank_mask:0xf
  v_fmac_f32_dpp v9, v7, v17 row_newbcast:11 row_mask:0xf bank_mask:0xf
  v_fmac_f32_dpp v10, v7, v18 row_newbcast:11 row_mask:0xf bank_mask:0xf
  v_fmac_f32_dpp v11, v7, v19 row_newbcast:11 row_mask:0xf bank_mask:0xf
  v_fmac_f32_dpp v12, v7, v20 row_newbcast:11 row_mask:0xf bank_mask:0xf
  v_fmac_f32_dpp v13, v7, v21 row_newbcast:11 row_mask:0xf bank_mask:0xf
  v_fmac_f32_dpp v14, v7, v22 row_newbcast:11 row_mask:0xf bank_mask:0xf
  v_fmac_f32_dpp v15, v7, v23 row_newbcast:11 row_mask:0xf bank_mask:0xf
  s_waitcnt vmcnt(1)
  v_lshlrev_b32 v16, 16, v136
  v_and_b32 v17, s12, v136
  v_lshlrev_b32 v18, 16, v137
  v_and_b32 v19, s12, v137
  v_lshlrev_b32 v20, 16, v138
  v_and_b32 v21, s12, v138
  v_lshlrev_b32 v22, 16, v139
  v_and_b32 v23, s12, v139
  v_fmac_f32_dpp v8, v7, v16 row_newbcast:7 row_mask:0xf bank_mask:0xf
  v_fmac_f32_dpp v9, v7, v17 row_newbcast:7 row_mask:0xf bank_mask:0xf
  v_fmac_f32_dpp v10, v7, v18 row_newbcast:7 row_mask:0xf bank_mask:0xf
  v_fmac_f32_dpp v11, v7, v19 row_newbcast:7 row_mask:0xf bank_mask:0xf
  v_fmac_f32_dpp v12, v7, v20 row_newbcast:7 row_mask:0xf bank_mask:0xf
  v_fmac_f32_dpp v13, v7, v21 row_newbcast:7 row_mask:0xf bank_mask:0xf
  v_fmac_f32_dpp v14, v7, v22 row_newbcast:7 row_mask:0xf bank_mask:0xf
  v_fmac_f32_dpp v15, v7, v23 row_newbcast:7 row_mask:0xf bank_mask:0xf
  s_waitcnt vmcnt(0)
  v_lshlrev_b32 v16, 16, v140
  v_and_b32 v17, s12, v140
  v_lshlrev_b32 v18, 16, v141
  v_and_b32 v19, s12, v141
  v_lshlrev_b32 v20, 16, v142
  v_and_b32 v21, s12, v142
  v_lshlrev_b32 v22, 16, v143
  v_and_b32 v23, s12, v143
  v_fmac_f32_dpp v8, v7, v16 row_newbcast:15 row_mask:0xf bank_mask:0xf
  v_fmac_f32_dpp v9, v7, v17 row_newbcast:15 row_mask:0xf bank_mask:0xf
  v_fmac_f32_dpp v10, v7, v18 row_newbcast:15 row_mask:0xf bank_mask:0xf
  v_fmac_f32_dpp v11, v7, v19 row_newbcast:15 row_mask:0xf bank_mask:0xf
  v_fmac_f32_dpp v12, v7, v20 row_newbcast:15 row_mask:0xf bank_mask:0xf
  v_fmac_f32_dpp v13, v7, v21 row_newbcast:15 row_mask:0xf bank_mask:0xf
  v_fmac_f32_dpp v14, v7, v22 row_newbcast:15 row_mask:0xf bank_mask:0xf
  v_fmac_f32_dpp v15, v7, v23 row_newbcast:15 row_mask:0xf bank_mask:0xf
  v_permlane32_swap_b32 v8, v12
  v_permlane32_swap_b32 v9, v13
  v_permlane32_swap_b32 v10, v14
  v_permlane32_swap_b32 v11, v15
  v_add_f32 v8, v8, v12
  v_add_f32 v9, v9, v13
  v_add_f32 v10, v10, v14
  v_add_f32 v11, v11, v15
  s_nop 0
  v_permlane16_swap_b32 v8, v10
  v_permlane16_swap_b32 v9, v11
  v_add_f32 v8, v8, v10
  v_add_f32 v9, v9, v11
  ds_write_b64 v2, v[8:9] offset:512
  s_waitcnt lgkmcnt(0)
  s_barrier
  s_endpgm
L_acini:
  s_mov_b32 s48, s38
  s_mov_b32 s49, s39
  s_mov_b32 s50, 2097152
  s_mov_b32 s51, 0x20000
  v_lshrrev_b32 v16, 2, v0
  v_lshlrev_b32 v16, 8, v16
  v_and_b32 v17, 3, v0
  v_lshl_add_u32 v16, v17, 4, v16
  v_mov_b32 v20, 0
  v_mov_b32 v21, 0x02000000
  v_mov_b32 v22, 0
  v_mov_b32 v23, 0x02000000
  s_lshl_b32 s9, s2, 12
  s_add_u32 s9, s9, 851968
  buffer_store_dwordx4 v[20:23], v16, s[48:51], s9 offen sc1
  buffer_store_dwordx4 v[20:23], v16, s[48:51], s9 offen offset:128 sc1
  s_nop 1
  s_branch L_acind
L_t0pub:
  v_mov_b32 v4, s46
  v_mov_b32 v5, s54
  s_lshl_b32 s9, s2, 3
  s_add_u32 s9, s9, 1016832
  s_mov_b64 exec, 1
  buffer_store_dwordx2 v[4:5], v24, s[48:51], s9 offen sc1
  s_mov_b64 exec, -1
  s_waitcnt vmcnt(0)
  s_branch L_t0pd
L_q_slow:
  s_cmp_lg_u32 s14, 24
  s_cbranch_scc1 L_q_sl2
  v_xor_b32 v96, s55, v96
  s_add_u32 s65, s65, 1048576
  buffer_store_dwordx4 v[96:99], v17, s[48:51], s65 offen sc1
L_q_sl2:
  s_cmp_gt_u32 s14, 262144
  s_cbranch_scc1 L_q_go
  s_xor_b32 s8, s8, 1048576
  s_xor_b32 s52, s52, 1048576
  s_xor_b32 s61, s61, s55
  s_xor_b32 s63, s63, s55
  v_mov_b32 v31, s61
  s_sleep 8
  s_branch L_q_poll
L_h_sst:
  buffer_store_dwordx4 v[48:51], v24, s[48:51], s62 offen sc1
  s_branch L_h_std
L_acw:
  v_and_b32 v16, 7, v0
  v_lshlrev_b32 v16, 3, v16
  s_mov_b32 s67, 1016832
  s_mov_b32 s14, 262144
L_acw_poll:
  buffer_load_dwordx2 v[4:5], v16, s[48:51], s67 offen sc1
  s_waitcnt vmcnt(0)
  v_cmp_ne_u32 vcc, s54, v5
  s_cbranch_vccz L_acw_go
  s_sleep 16
  s_sub_u32 s14, s14, 1
  s_cbranch_scc0 L_acw_poll
L_acw_go:
  s_branch L_acwd
L_o_sst:
  buffer_store_dwordx2 v[80:81], v20, s[48:51], s9 offen sc1
  s_branch L_o_std
L_bre:
  s_mov_b32 s14, 262144
L_bre2:
  s_mov_b64 exec, -1
  v_mov_b32 v152, 0
  v_mov_b32 v153, 0
  v_mov_b32 v154, 0
  v_mov_b32 v155, 0
  v_mov_b32 v156, 0
  v_mov_b32 v157, 0
  v_mov_b32 v158, 0
  v_mov_b32 v159, 0
  buffer_atomic_add_x2 v[152:153], v15, s[48:51], s65 offen offset:0 sc0 sc1
  buffer_atomic_add_x2 v[154:155], v15, s[48:51], s65 offen offset:128 sc0 sc1
  buffer_atomic_add_x2 v[156:157], v15, s[48:51], s65 offen offset:2048 sc0 sc1
  buffer_atomic_add_x2 v[158:159], v15, s[48:51], s65 offen offset:2176 sc0 sc1
  s_waitcnt vmcnt(0)
  s_mov_b64 s[24:25], 0
  v_cmp_le_i32 vcc, 0, v153
  s_lshr_b64 s[26:27], vcc, 4
  s_and_b64 s[26:27], s[26:27], s[16:17]
  s_or_b64 s[24:25], s[24:25], s[26:27]
  v_cmp_le_i32 vcc, 0, v155
  s_lshr_b64 s[26:27], vcc, 4
  s_and_b64 s[26:27], s[26:27], s[18:19]
  s_or_b64 s[24:25], s[24:25], s[26:27]
  v_cmp_le_i32 vcc, 0, v157
  s_lshr_b64 s[26:27], vcc, 4
  s_and_b64 s[26:27], s[26:27], s[20:21]
  s_or_b64 s[24:25], s[24:25], s[26:27]
  v_cmp_le_i32 vcc, 0, v159
  s_lshr_b64 s[26:27], vcc, 4
  s_and_b64 s[26:27], s[26:27], s[22:23]
  s_or_b64 s[24:25], s[24:25], s[26:27]
  s_sub_u32 s14, s14, 1
  s_cbranch_scc1 L_bre3
  s_and_b64 s[24:25], s[24:25], s[34:35]
  s_cbranch_scc1 L_bre2
L_bre3:
  v_add_u32 v153, s33, v153
  v_add_u32 v155, s33, v155
  v_add_u32 v157, s33, v157
  v_add_u32 v159, s33, v159
  v_add_f64 v[152:153], v[152:153], -s[68:69]
  v_add_f64 v[154:155], v[154:155], -s[68:69]
  v_add_f64 v[156:157], v[156:157], -s[68:69]
  v_add_f64 v[158:159], v[158:159], -s[68:69]
  v_cvt_f32_f64 v4, v[152:153]
  v_cvt_f32_f64 v5, v[154:155]
  v_cvt_f32_f64 v6, v[156:157]
  v_cvt_f32_f64 v7, v[158:159]
  v_cvt_pk_bf16_f32 v8, v4, v5
  v_lshlrev_b32 v4, 16, v8
  v_and_b32 v5, s12, v8
  v_cvt_pk_bf16_f32 v9, v6, v7
  v_lshlrev_b32 v6, 16, v9
  v_and_b32 v7, s12, v9
  v_add_f32 v8, v82, v4
  v_add_f32 v9, v83, v5
  v_add_f32 v10, v84, v6
  v_add_f32 v11, v85, v7
  v_cvt_pk_bf16_f32 v12, v8, v9
  v_lshlrev_b32 v8, 16, v12
  v_and_b32 v9, s12, v12
  v_cvt_pk_bf16_f32 v13, v10, v11
  v_lshlrev_b32 v10, 16, v13
  v_and_b32 v11, s12, v13
  v_add_f32_dpp v8, v4, v8 row_shl:4 row_mask:0xf bank_mask:0x5
  v_add_f32_dpp v9, v5, v9 row_shl:4 row_mask:0xf bank_mask:0x5
  v_add_f32_dpp v10, v6, v10 row_shl:4 row_mask:0xf bank_mask:0x5
  v_add_f32_dpp v11, v7, v11 row_shl:4 row_mask:0xf bank_mask:0x5
  v_cvt_pk_bf16_f32 v8, v8, v9
  v_cvt_pk_bf16_f32 v10, v10, v11
  s_and_b64 exec, s[22:23], s[34:35]
  s_cbranch_scc0 L_at_s3r
  buffer_store_short_d16_hi v10, v22, s[44:47], 0 offen offset:6
L_at_s3r:
  s_and_b64 exec, s[20:21], s[34:35]
  s_cbranch_scc0 L_at_s2r
  buffer_store_short v10, v22, s[44:47], 0 offen offset:4
L_at_s2r:
  s_and_b64 exec, s[18:19], s[34:35]
  s_cbranch_scc0 L_at_s1r
  buffer_store_short_d16_hi v8, v22, s[44:47], 0 offen offset:2
L_at_s1r:
  s_and_b64 exec, s[16:17], s[34:35]
  s_cbranch_scc0 L_at_s0r
  buffer_store_short v8, v22, s[44:47], 0 offen offset:0
L_at_s0r:
  s_branch L_bred
L_f_slow:
  s_cmp_lg_u32 s14, 24
  s_cbranch_scc1 L_f_sl2
  v_xor_b32 v96, s55, v96
  s_add_u32 s66, s66, 1048576
  buffer_store_dwordx4 v[96:99], v3, s[48:51], s66 offen sc1
L_f_sl2:
  s_cmp_gt_u32 s14, 262144
  s_cbranch_scc1 L_f_go
  s_xor_b32 s8, s8, 1048576
  s_xor_b32 s10, s10, 1048576
  s_xor_b32 s52, s52, 1048576
  s_xor_b32 s61, s61, s55
  s_xor_b32 s63, s63, s55
  v_mov_b32 v31, s61
  s_sleep 8
  s_branch L_f_poll
L_pcwe4:
  s_memrealtime s[22:23]
  s_branch L_pce4
L_pcwe5:
  s_memrealtime s[22:23]
  s_branch L_pce5
L_pcwe6:
  s_memrealtime s[22:23]
  s_branch L_pce6
L_pcwe7:
  s_memrealtime s[22:23]
  s_branch L_pce7
L_pcwe8:
  s_memrealtime s[22:23]
  s_branch L_pce8
L_pcwe9:
  s_memrealtime s[22:23]
  s_branch L_pce9
L_pcwe10:
  s_memrealtime s[22:23]
  s_branch L_pce10
L_pcwe11:
  s_memrealtime s[22:23]
  s_branch L_pce11
L_pcwe12:
  s_memrealtime s[22:23]
  s_branch L_pce12
L_pcwe13:
  s_memrealtime s[22:23]
  s_branch L_pce13
L_pcwe14:
  s_memrealtime s[22:23]
  s_branch L_pce14
L_pcwe15:
  s_memrealtime s[22:23]
  s_branch L_pce15
L_pcwe16:
  s_memrealtime s[22:23]
  s_waitcnt lgkmcnt(0)
  s_sub_u32 s26, s22, s24
  s_cmp_lt_u32 s26, 552
  s_cbranch_scc1 L_pcwe16
  s_getreg_b32 s27, hwreg(HW_REG_IB_STS, 0, 4)
  s_sub_u32 s24, s24, s15
  s_lshr_b32 s26, s15, 4
  s_sub_u32 s15, s15, s26
  s_cmp_ge_u32 s27, 3
  s_cselect_b32 s27, 8, -1
  s_add_i32 s15, s15, s27
  s_max_i32 s15, s15, 0
  s_add_u32 s24, s24, s15
  s_branch L_pce16
L_pcwe17:
  s_memrealtime s[22:23]
  s_waitcnt lgkmcnt(0)
  s_sub_u32 s26, s22, s24
  s_cmp_lt_u32 s26, 578
  s_cbranch_scc1 L_pcwe17
  s_getreg_b32 s27, hwreg(HW_REG_IB_STS, 0, 4)
  s_sub_u32 s24, s24, s15
  s_lshr_b32 s26, s15, 4
  s_sub_u32 s15, s15, s26
  s_cmp_ge_u32 s27, 3
  s_cselect_b32 s27, 8, -1
  s_add_i32 s15, s15, s27
  s_max_i32 s15, s15, 0
  s_add_u32 s24, s24, s15
  s_branch L_pce17
L_pcwe18:
  s_memrealtime s[22:23]
  s_waitcnt lgkmcnt(0)
  s_sub_u32 s26, s22, s24
  s_cmp_lt_u32 s26, 604
  s_cbranch_scc1 L_pcwe18
  s_getreg_b32 s27, hwreg(HW_REG_IB_STS, 0, 4)
  s_sub_u32 s24, s24, s15
  s_lshr_b32 s26, s15, 4
  s_sub_u32 s15, s15, s26
  s_cmp_ge_u32 s27, 3
  s_cselect_b32 s27, 8, -1
  s_add_i32 s15, s15, s27
  s_max_i32 s15, s15, 0
  s_add_u32 s24, s24, s15
  s_branch L_pce18
L_pcwe19:
  s_memrealtime s[22:23]
  s_waitcnt lgkmcnt(0)
  s_sub_u32 s26, s22, s24
  s_cmp_lt_u32 s26, 630
  s_cbranch_scc1 L_pcwe19
  s_getreg_b32 s27, hwreg(HW_REG_IB_STS, 0, 4)
  s_sub_u32 s24, s24, s15
  s_lshr_b32 s26, s15, 4
  s_sub_u32 s15, s15, s26
  s_cmp_ge_u32 s27, 3
  s_cselect_b32 s27, 8, -1
  s_add_i32 s15, s15, s27
  s_max_i32 s15, s15, 0
  s_add_u32 s24, s24, s15
  s_branch L_pce19
L_pcwe20:
  s_memrealtime s[22:23]
  s_waitcnt lgkmcnt(0)
  s_sub_u32 s26, s22, s24
  s_cmp_lt_u32 s26, 656
  s_cbranch_scc1 L_pcwe20
  s_getreg_b32 s27, hwreg(HW_REG_IB_STS, 0, 4)
  s_sub_u32 s24, s24, s15
  s_lshr_b32 s26, s15, 4
  s_sub_u32 s15, s15, s26
  s_cmp_ge_u32 s27, 3
  s_cselect_b32 s27, 8, -1
  s_add_i32 s15, s15, s27
  s_max_i32 s15, s15, 0
  s_add_u32 s24, s24, s15
  s_branch L_pce20
L_pcwe21:
  s_memrealtime s[22:23]
  s_waitcnt lgkmcnt(0)
  s_sub_u32 s26, s22, s24
  s_cmp_lt_u32 s26, 682
  s_cbranch_scc1 L_pcwe21
  s_getreg_b32 s27, hwreg(HW_REG_IB_STS, 0, 4)
  s_sub_u32 s24, s24, s15
  s_lshr_b32 s26, s15, 4
  s_sub_u32 s15, s15, s26
  s_cmp_ge_u32 s27, 3
  s_cselect_b32 s27, 8, -1
  s_add_i32 s15, s15, s27
  s_max_i32 s15, s15, 0
  s_add_u32 s24, s24, s15
  s_branch L_pce21
L_pcwe22:
  s_memrealtime s[22:23]
  s_waitcnt lgkmcnt(0)
  s_sub_u32 s26, s22, s24
  s_cmp_lt_u32 s26, 708
  s_cbranch_scc1 L_pcwe22
  s_getreg_b32 s27, hwreg(HW_REG_IB_STS, 0, 4)
  s_sub_u32 s24, s24, s15
  s_lshr_b32 s26, s15, 4
  s_sub_u32 s15, s15, s26
  s_cmp_ge_u32 s27, 3
  s_cselect_b32 s27, 8, -1
  s_add_i32 s15, s15, s27
  s_max_i32 s15, s15, 0
  s_add_u32 s24, s24, s15
  s_branch L_pce22
L_pcwe23:
  s_memrealtime s[22:23]
  s_waitcnt lgkmcnt(0)
  s_sub_u32 s26, s22, s24
  s_cmp_lt_u32 s26, 734
  s_cbranch_scc1 L_pcwe23
  s_getreg_b32 s27, hwreg(HW_REG_IB_STS, 0, 4)
  s_sub_u32 s24, s24, s15
  s_lshr_b32 s26, s15, 4
  s_sub_u32 s15, s15, s26
  s_cmp_ge_u32 s27, 3
  s_cselect_b32 s27, 8, -1
  s_add_i32 s15, s15, s27
  s_max_i32 s15, s15, 0
  s_add_u32 s24, s24, s15
  s_branch L_pce23
L_pcwe24:
  s_memrealtime s[22:23]
  s_waitcnt lgkmcnt(0)
  s_sub_u32 s26, s22, s24
  s_cmp_lt_u32 s26, 760
  s_cbranch_scc1 L_pcwe24
  s_getreg_b32 s27, hwreg(HW_REG_IB_STS, 0, 4)
  s_sub_u32 s24, s24, s15
  s_lshr_b32 s26, s15, 4
  s_sub_u32 s15, s15, s26
  s_cmp_ge_u32 s27, 3
  s_cselect_b32 s27, 8, -1
  s_add_i32 s15, s15, s27
  s_max_i32 s15, s15, 0
  s_add_u32 s24, s24, s15
  s_branch L_pce24
L_pcwe25:
  s_memrealtime s[22:23]
  s_waitcnt lgkmcnt(0)
  s_sub_u32 s26, s22, s24
  s_cmp_lt_u32 s26, 786
  s_cbranch_scc1 L_pcwe25
  s_getreg_b32 s27, hwreg(HW_REG_IB_STS, 0, 4)
  s_sub_u32 s24, s24, s15
  s_lshr_b32 s26, s15, 4
  s_sub_u32 s15, s15, s26
  s_cmp_ge_u32 s27, 3
  s_cselect_b32 s27, 8, -1
  s_add_i32 s15, s15, s27
  s_max_i32 s15, s15, 0
  s_add_u32 s24, s24, s15
  s_branch L_pce25
L_pcwe26:
  s_memrealtime s[22:23]
  s_waitcnt lgkmcnt(0)
  s_sub_u32 s26, s22, s24
  s_cmp_lt_u32 s26, 812
  s_cbranch_scc1 L_pcwe26
  s_getreg_b32 s27, hwreg(HW_REG_IB_STS, 0, 4)
  s_sub_u32 s24, s24, s15
  s_lshr_b32 s26, s15, 4
  s_sub_u32 s15, s15, s26
  s_cmp_ge_u32 s27, 3
  s_cselect_b32 s27, 8, -1
  s_add_i32 s15, s15, s27
  s_max_i32 s15, s15, 0
  s_add_u32 s24, s24, s15
  s_branch L_pce26
L_pcwe27:
  s_memrealtime s[22:23]
  s_waitcnt lgkmcnt(0)
  s_sub_u32 s26, s22, s24
  s_cmp_lt_u32 s26, 838
  s_cbranch_scc1 L_pcwe27
  s_getreg_b32 s27, hwreg(HW_REG_IB_STS, 0, 4)
  s_sub_u32 s24, s24, s15
  s_lshr_b32 s26, s15, 4
  s_sub_u32 s15, s15, s26
  s_cmp_ge_u32 s27, 3
  s_cselect_b32 s27, 8, -1
  s_add_i32 s15, s15, s27
  s_max_i32 s15, s15, 0
  s_add_u32 s24, s24, s15
  s_branch L_pce27
L_pcwe28:
  s_memrealtime s[22:23]
  s_waitcnt lgkmcnt(0)
  s_sub_u32 s26, s22, s24
  s_cmp_lt_u32 s26, 863
  s_cbranch_scc1 L_pcwe28
  s_getreg_b32 s27, hwreg(HW_REG_IB_STS, 0, 4)
  s_sub_u32 s24, s24, s15
  s_lshr_b32 s26, s15, 4
  s_sub_u32 s15, s15, s26
  s_cmp_ge_u32 s27, 3
  s_cselect_b32 s27, 8, -1
  s_add_i32 s15, s15, s27
  s_max_i32 s15, s15, 0
  s_add_u32 s24, s24, s15
  s_branch L_pce28
L_pcwe29:
  s_memrealtime s[22:23]
  s_waitcnt lgkmcnt(0)
  s_sub_u32 s26, s22, s24
  s_cmp_lt_u32 s26, 889
  s_cbranch_scc1 L_pcwe29
  s_getreg_b32 s27, hwreg(HW_REG_IB_STS, 0, 4)
  s_sub_u32 s24, s24, s15
  s_lshr_b32 s26, s15, 4
  s_sub_u32 s15, s15, s26
  s_cmp_ge_u32 s27, 3
  s_cselect_b32 s27, 8, -1
  s_add_i32 s15, s15, s27
  s_max_i32 s15, s15, 0
  s_add_u32 s24, s24, s15
  s_branch L_pce29
L_pcwe30:
  s_memrealtime s[22:23]
  s_waitcnt lgkmcnt(0)
  s_sub_u32 s26, s22, s24
  s_cmp_lt_u32 s26, 915
  s_cbranch_scc1 L_pcwe30
  s_getreg_b32 s27, hwreg(HW_REG_IB_STS, 0, 4)
  s_sub_u32 s24, s24, s15
  s_lshr_b32 s26, s15, 4
  s_sub_u32 s15, s15, s26
  s_cmp_ge_u32 s27, 3
  s_cselect_b32 s27, 8, -1
  s_add_i32 s15, s15, s27
  s_max_i32 s15, s15, 0
  s_add_u32 s24, s24, s15
  s_branch L_pce30
L_pcwe31:
  s_memrealtime s[22:23]
  s_waitcnt lgkmcnt(0)
  s_sub_u32 s26, s22, s24
  s_cmp_lt_u32 s26, 941
  s_cbranch_scc1 L_pcwe31
  s_getreg_b32 s27, hwreg(HW_REG_IB_STS, 0, 4)
  s_sub_u32 s24, s24, s15
  s_lshr_b32 s26, s15, 4
  s_sub_u32 s15, s15, s26
  s_cmp_ge_u32 s27, 3
  s_cselect_b32 s27, 8, -1
  s_add_i32 s15, s15, s27
  s_max_i32 s15, s15, 0
  s_add_u32 s24, s24, s15
  s_branch L_pce31
L_pcwe32:
  s_memrealtime s[22:23]
  s_waitcnt lgkmcnt(0)
  s_sub_u32 s26, s22, s24
  s_cmp_lt_u32 s26, 967
  s_cbranch_scc1 L_pcwe32
  s_getreg_b32 s27, hwreg(HW_REG_IB_STS, 0, 4)
  s_sub_u32 s24, s24, s15
  s_lshr_b32 s26, s15, 4
  s_sub_u32 s15, s15, s26
  s_cmp_ge_u32 s27, 3
  s_cselect_b32 s27, 8, -1
  s_add_i32 s15, s15, s27
  s_max_i32 s15, s15, 0
  s_add_u32 s24, s24, s15
  s_branch L_pce32
L_pcwe33:
  s_memrealtime s[22:23]
  s_waitcnt lgkmcnt(0)
  s_sub_u32 s26, s22, s24
  s_cmp_lt_u32 s26, 993
  s_cbranch_scc1 L_pcwe33
  s_getreg_b32 s27, hwreg(HW_REG_IB_STS, 0, 4)
  s_sub_u32 s24, s24, s15
  s_lshr_b32 s26, s15, 4
  s_sub_u32 s15, s15, s26
  s_cmp_ge_u32 s27, 3
  s_cselect_b32 s27, 8, -1
  s_add_i32 s15, s15, s27
  s_max_i32 s15, s15, 0
  s_add_u32 s24, s24, s15
  s_branch L_pce33
L_pcwe34:
  s_memrealtime s[22:23]
  s_waitcnt lgkmcnt(0)
  s_sub_u32 s26, s22, s24
  s_cmp_lt_u32 s26, 1019
  s_cbranch_scc1 L_pcwe34
  s_getreg_b32 s27, hwreg(HW_REG_IB_STS, 0, 4)
  s_sub_u32 s24, s24, s15
  s_lshr_b32 s26, s15, 4
  s_sub_u32 s15, s15, s26
  s_cmp_ge_u32 s27, 3
  s_cselect_b32 s27, 8, -1
  s_add_i32 s15, s15, s27
  s_max_i32 s15, s15, 0
  s_add_u32 s24, s24, s15
  s_branch L_pce34
L_pcwe35:
  s_memrealtime s[22:23]
  s_waitcnt lgkmcnt(0)
  s_sub_u32 s26, s22, s24
  s_cmp_lt_u32 s26, 1045
  s_cbranch_scc1 L_pcwe35
  s_getreg_b32 s27, hwreg(HW_REG_IB_STS, 0, 4)
  s_sub_u32 s24, s24, s15
  s_lshr_b32 s26, s15, 4
  s_sub_u32 s15, s15, s26
  s_cmp_ge_u32 s27, 3
  s_cselect_b32 s27, 8, -1
  s_add_i32 s15, s15, s27
  s_max_i32 s15, s15, 0
  s_add_u32 s24, s24, s15
  s_branch L_pce35
L_pcwe36:
  s_memrealtime s[22:23]
  s_waitcnt lgkmcnt(0)
  s_sub_u32 s26, s22, s24
  s_cmp_lt_u32 s26, 1071
  s_cbranch_scc1 L_pcwe36
  s_getreg_b32 s27, hwreg(HW_REG_IB_STS, 0, 4)
  s_sub_u32 s24, s24, s15
  s_lshr_b32 s26, s15, 4
  s_sub_u32 s15, s15, s26
  s_cmp_ge_u32 s27, 3
  s_cselect_b32 s27, 8, -1
  s_add_i32 s15, s15, s27
  s_max_i32 s15, s15, 0
  s_add_u32 s24, s24, s15
  s_branch L_pce36
L_pcwe37:
  s_memrealtime s[22:23]
  s_waitcnt lgkmcnt(0)
  s_sub_u32 s26, s22, s24
  s_cmp_lt_u32 s26, 1097
  s_cbranch_scc1 L_pcwe37
  s_getreg_b32 s27, hwreg(HW_REG_IB_STS, 0, 4)
  s_sub_u32 s24, s24, s15
  s_lshr_b32 s26, s15, 4
  s_sub_u32 s15, s15, s26
  s_cmp_ge_u32 s27, 3
  s_cselect_b32 s27, 8, -1
  s_add_i32 s15, s15, s27
  s_max_i32 s15, s15, 0
  s_add_u32 s24, s24, s15
  s_branch L_pce37
L_pcwe38:
  s_memrealtime s[22:23]
  s_waitcnt lgkmcnt(0)
  s_sub_u32 s26, s22, s24
  s_cmp_lt_u32 s26, 1123
  s_cbranch_scc1 L_pcwe38
  s_getreg_b32 s27, hwreg(HW_REG_IB_STS, 0, 4)
  s_sub_u32 s24, s24, s15
  s_lshr_b32 s26, s15, 4
  s_sub_u32 s15, s15, s26
  s_cmp_ge_u32 s27, 3
  s_cselect_b32 s27, 8, -1
  s_add_i32 s15, s15, s27
  s_max_i32 s15, s15, 0
  s_add_u32 s24, s24, s15
  s_branch L_pce38
L_pcwe39:
  s_memrealtime s[22:23]
  s_waitcnt lgkmcnt(0)
  s_sub_u32 s26, s22, s24
  s_cmp_lt_u32 s26, 1149
  s_cbranch_scc1 L_pcwe39
  s_getreg_b32 s27, hwreg(HW_REG_IB_STS, 0, 4)
  s_sub_u32 s24, s24, s15
  s_lshr_b32 s26, s15, 4
  s_sub_u32 s15, s15, s26
  s_cmp_ge_u32 s27, 3
  s_cselect_b32 s27, 8, -1
  s_add_i32 s15, s15, s27
  s_max_i32 s15, s15, 0
  s_add_u32 s24, s24, s15
  s_branch L_pce39
L_pcwe40:
  s_memrealtime s[22:23]
  s_waitcnt lgkmcnt(0)
  s_sub_u32 s26, s22, s24
  s_cmp_lt_u32 s26, 1175
  s_cbranch_scc1 L_pcwe40
  s_getreg_b32 s27, hwreg(HW_REG_IB_STS, 0, 4)
  s_sub_u32 s24, s24, s15
  s_lshr_b32 s26, s15, 4
  s_sub_u32 s15, s15, s26
  s_cmp_ge_u32 s27, 3
  s_cselect_b32 s27, 8, -1
  s_add_i32 s15, s15, s27
  s_max_i32 s15, s15, 0
  s_add_u32 s24, s24, s15
  s_branch L_pce40
L_pcwe41:
  s_memrealtime s[22:23]
  s_waitcnt lgkmcnt(0)
  s_sub_u32 s26, s22, s24
  s_cmp_lt_u32 s26, 1201
  s_cbranch_scc1 L_pcwe41
  s_getreg_b32 s27, hwreg(HW_REG_IB_STS, 0, 4)
  s_sub_u32 s24, s24, s15
  s_lshr_b32 s26, s15, 4
  s_sub_u32 s15, s15, s26
  s_cmp_ge_u32 s27, 3
  s_cselect_b32 s27, 8, -1
  s_add_i32 s15, s15, s27
  s_max_i32 s15, s15, 0
  s_add_u32 s24, s24, s15
  s_branch L_pce41
L_pcwe42:
  s_memrealtime s[22:23]
  s_waitcnt lgkmcnt(0)
  s_sub_u32 s26, s22, s24
  s_cmp_lt_u32 s26, 1227
  s_cbranch_scc1 L_pcwe42
  s_getreg_b32 s27, hwreg(HW_REG_IB_STS, 0, 4)
  s_sub_u32 s24, s24, s15
  s_lshr_b32 s26, s15, 4
  s_sub_u32 s15, s15, s26
  s_cmp_ge_u32 s27, 3
  s_cselect_b32 s27, 8, -1
  s_add_i32 s15, s15, s27
  s_max_i32 s15, s15, 0
  s_add_u32 s24, s24, s15
  s_branch L_pce42
L_pcwe43:
  s_memrealtime s[22:23]
  s_waitcnt lgkmcnt(0)
  s_sub_u32 s26, s22, s24
  s_cmp_lt_u32 s26, 1253
  s_cbranch_scc1 L_pcwe43
  s_getreg_b32 s27, hwreg(HW_REG_IB_STS, 0, 4)
  s_sub_u32 s24, s24, s15
  s_lshr_b32 s26, s15, 4
  s_sub_u32 s15, s15, s26
  s_cmp_ge_u32 s27, 3
  s_cselect_b32 s27, 8, -1
  s_add_i32 s15, s15, s27
  s_max_i32 s15, s15, 0
  s_add_u32 s24, s24, s15
  s_branch L_pce43
L_pcwe44:
  s_memrealtime s[22:23]
  s_waitcnt lgkmcnt(0)
  s_sub_u32 s26, s22, s24
  s_cmp_lt_u32 s26, 1279
  s_cbranch_scc1 L_pcwe44
  s_getreg_b32 s27, hwreg(HW_REG_IB_STS, 0, 4)
  s_sub_u32 s24, s24, s15
  s_lshr_b32 s26, s15, 4
  s_sub_u32 s15, s15, s26
  s_cmp_ge_u32 s27, 3
  s_cselect_b32 s27, 8, -1
  s_add_i32 s15, s15, s27
  s_max_i32 s15, s15, 0
  s_add_u32 s24, s24, s15
  s_branch L_pce44
L_pcwe45:
  s_memrealtime s[22:23]
  s_waitcnt lgkmcnt(0)
  s_sub_u32 s26, s22, s24
  s_cmp_lt_u32 s26, 1305
  s_cbranch_scc1 L_pcwe45
  s_getreg_b32 s27, hwreg(HW_REG_IB_STS, 0, 4)
  s_sub_u32 s24, s24, s15
  s_lshr_b32 s26, s15, 4
  s_sub_u32 s15, s15, s26
  s_cmp_ge_u32 s27, 3
  s_cselect_b32 s27, 8, -1
  s_add_i32 s15, s15, s27
  s_max_i32 s15, s15, 0
  s_add_u32 s24, s24, s15
  s_branch L_pce45
L_pcwe46:
  s_memrealtime s[22:23]
  s_waitcnt lgkmcnt(0)
  s_sub_u32 s26, s22, s24
  s_cmp_lt_u32 s26, 1331
  s_cbranch_scc1 L_pcwe46
  s_getreg_b32 s27, hwreg(HW_REG_IB_STS, 0, 4)
  s_sub_u32 s24, s24, s15
  s_lshr_b32 s26, s15, 4
  s_sub_u32 s15, s15, s26
  s_cmp_ge_u32 s27, 3
  s_cselect_b32 s27, 8, -1
  s_add_i32 s15, s15, s27
  s_max_i32 s15, s15, 0
  s_add_u32 s24, s24, s15
  s_branch L_pce46
L_pcwe47:
  s_memrealtime s[22:23]
  s_waitcnt lgkmcnt(0)
  s_sub_u32 s26, s22, s24
  s_cmp_lt_u32 s26, 1357
  s_cbranch_scc1 L_pcwe47
  s_getreg_b32 s27, hwreg(HW_REG_IB_STS, 0, 4)
  s_sub_u32 s24, s24, s15
  s_lshr_b32 s26, s15, 4
  s_sub_u32 s15, s15, s26
  s_cmp_ge_u32 s27, 3
  s_cselect_b32 s27, 8, -1
  s_add_i32 s15, s15, s27
  s_max_i32 s15, s15, 0
  s_add_u32 s24, s24, s15
  s_branch L_pce47
L_pcwe48:
  s_memrealtime s[22:23]
  s_waitcnt lgkmcnt(0)
  s_sub_u32 s26, s22, s24
  s_cmp_lt_u32 s26, 1383
  s_cbranch_scc1 L_pcwe48
  s_getreg_b32 s27, hwreg(HW_REG_IB_STS, 0, 4)
  s_sub_u32 s24, s24, s15
  s_lshr_b32 s26, s15, 4
  s_sub_u32 s15, s15, s26
  s_cmp_ge_u32 s27, 3
  s_cselect_b32 s27, 8, -1
  s_add_i32 s15, s15, s27
  s_max_i32 s15, s15, 0
  s_add_u32 s24, s24, s15
  s_branch L_pce48
L_pcwe49:
  s_memrealtime s[22:23]
  s_waitcnt lgkmcnt(0)
  s_sub_u32 s26, s22, s24
  s_cmp_lt_u32 s26, 1409
  s_cbranch_scc1 L_pcwe49
  s_getreg_b32 s27, hwreg(HW_REG_IB_STS, 0, 4)
  s_sub_u32 s24, s24, s15
  s_lshr_b32 s26, s15, 4
  s_sub_u32 s15, s15, s26
  s_cmp_ge_u32 s27, 3
  s_cselect_b32 s27, 8, -1
  s_add_i32 s15, s15, s27
  s_max_i32 s15, s15, 0
  s_add_u32 s24, s24, s15
  s_branch L_pce49
L_pcwe50:
  s_memrealtime s[22:23]
  s_waitcnt lgkmcnt(0)
  s_sub_u32 s26, s22, s24
  s_cmp_lt_u32 s26, 1435
  s_cbranch_scc1 L_pcwe50
  s_getreg_b32 s27, hwreg(HW_REG_IB_STS, 0, 4)
  s_sub_u32 s24, s24, s15
  s_lshr_b32 s26, s15, 4
  s_sub_u32 s15, s15, s26
  s_cmp_ge_u32 s27, 3
  s_cselect_b32 s27, 8, -1
  s_add_i32 s15, s15, s27
  s_max_i32 s15, s15, 0
  s_add_u32 s24, s24, s15
  s_branch L_pce50
L_pcwe51:
  s_memrealtime s[22:23]
  s_waitcnt lgkmcnt(0)
  s_sub_u32 s26, s22, s24
  s_cmp_lt_u32 s26, 1461
  s_cbranch_scc1 L_pcwe51
  s_getreg_b32 s27, hwreg(HW_REG_IB_STS, 0, 4)
  s_sub_u32 s24, s24, s15
  s_lshr_b32 s26, s15, 4
  s_sub_u32 s15, s15, s26
  s_cmp_ge_u32 s27, 3
  s_cselect_b32 s27, 8, -1
  s_add_i32 s15, s15, s27
  s_max_i32 s15, s15, 0
  s_add_u32 s24, s24, s15
  s_branch L_pce51
L_pcwe52:
  s_memrealtime s[22:23]
  s_waitcnt lgkmcnt(0)
  s_sub_u32 s26, s22, s24
  s_cmp_lt_u32 s26, 1486
  s_cbranch_scc1 L_pcwe52
  s_getreg_b32 s27, hwreg(HW_REG_IB_STS, 0, 4)
  s_sub_u32 s24, s24, s15
  s_lshr_b32 s26, s15, 4
  s_sub_u32 s15, s15, s26
  s_cmp_ge_u32 s27, 3
  s_cselect_b32 s27, 8, -1
  s_add_i32 s15, s15, s27
  s_max_i32 s15, s15, 0
  s_add_u32 s24, s24, s15
  s_branch L_pce52
L_pcwe53:
  s_memrealtime s[22:23]
  s_waitcnt lgkmcnt(0)
  s_sub_u32 s26, s22, s24
  s_cmp_lt_u32 s26, 1512
  s_cbranch_scc1 L_pcwe53
  s_getreg_b32 s27, hwreg(HW_REG_IB_STS, 0, 4)
  s_sub_u32 s24, s24, s15
  s_lshr_b32 s26, s15, 4
  s_sub_u32 s15, s15, s26
  s_cmp_ge_u32 s27, 3
  s_cselect_b32 s27, 8, -1
  s_add_i32 s15, s15, s27
  s_max_i32 s15, s15, 0
  s_add_u32 s24, s24, s15
  s_branch L_pce53
L_pcwe54:
  s_memrealtime s[22:23]
  s_waitcnt lgkmcnt(0)
  s_sub_u32 s26, s22, s24
  s_cmp_lt_u32 s26, 1538
  s_cbranch_scc1 L_pcwe54
  s_getreg_b32 s27, hwreg(HW_REG_IB_STS, 0, 4)
  s_sub_u32 s24, s24, s15
  s_lshr_b32 s26, s15, 4
  s_sub_u32 s15, s15, s26
  s_cmp_ge_u32 s27, 3
  s_cselect_b32 s27, 8, -1
  s_add_i32 s15, s15, s27
  s_max_i32 s15, s15, 0
  s_add_u32 s24, s24, s15
  s_branch L_pce54
L_pcwe55:
  s_memrealtime s[22:23]
  s_waitcnt lgkmcnt(0)
  s_sub_u32 s26, s22, s24
  s_cmp_lt_u32 s26, 1564
  s_cbranch_scc1 L_pcwe55
  s_getreg_b32 s27, hwreg(HW_REG_IB_STS, 0, 4)
  s_sub_u32 s24, s24, s15
  s_lshr_b32 s26, s15, 4
  s_sub_u32 s15, s15, s26
  s_cmp_ge_u32 s27, 3
  s_cselect_b32 s27, 8, -1
  s_add_i32 s15, s15, s27
  s_max_i32 s15, s15, 0
  s_add_u32 s24, s24, s15
  s_branch L_pce55
L_pcwe56:
  s_memrealtime s[22:23]
  s_waitcnt lgkmcnt(0)
  s_sub_u32 s26, s22, s24
  s_cmp_lt_u32 s26, 1590
  s_cbranch_scc1 L_pcwe56
  s_getreg_b32 s27, hwreg(HW_REG_IB_STS, 0, 4)
  s_sub_u32 s24, s24, s15
  s_lshr_b32 s26, s15, 4
  s_sub_u32 s15, s15, s26
  s_cmp_ge_u32 s27, 3
  s_cselect_b32 s27, 8, -1
  s_add_i32 s15, s15, s27
  s_max_i32 s15, s15, 0
  s_add_u32 s24, s24, s15
  s_branch L_pce56
L_pcwe57:
  s_memrealtime s[22:23]
  s_waitcnt lgkmcnt(0)
  s_sub_u32 s26, s22, s24
  s_cmp_lt_u32 s26, 1616
  s_cbranch_scc1 L_pcwe57
  s_getreg_b32 s27, hwreg(HW_REG_IB_STS, 0, 4)
  s_sub_u32 s24, s24, s15
  s_lshr_b32 s26, s15, 4
  s_sub_u32 s15, s15, s26
  s_cmp_ge_u32 s27, 3
  s_cselect_b32 s27, 8, -1
  s_add_i32 s15, s15, s27
  s_max_i32 s15, s15, 0
  s_add_u32 s24, s24, s15
  s_branch L_pce57
L_pcwe58:
  s_memrealtime s[22:23]
  s_waitcnt lgkmcnt(0)
  s_sub_u32 s26, s22, s24
  s_cmp_lt_u32 s26, 1642
  s_cbranch_scc1 L_pcwe58
  s_getreg_b32 s27, hwreg(HW_REG_IB_STS, 0, 4)
  s_sub_u32 s24, s24, s15
  s_lshr_b32 s26, s15, 4
  s_sub_u32 s15, s15, s26
  s_cmp_ge_u32 s27, 3
  s_cselect_b32 s27, 8, -1
  s_add_i32 s15, s15, s27
  s_max_i32 s15, s15, 0
  s_add_u32 s24, s24, s15
  s_branch L_pce58
L_pcwe59:
  s_memrealtime s[22:23]
  s_waitcnt lgkmcnt(0)
  s_sub_u32 s26, s22, s24
  s_cmp_lt_u32 s26, 1668
  s_cbranch_scc1 L_pcwe59
  s_getreg_b32 s27, hwreg(HW_REG_IB_STS, 0, 4)
  s_sub_u32 s24, s24, s15
  s_lshr_b32 s26, s15, 4
  s_sub_u32 s15, s15, s26
  s_cmp_ge_u32 s27, 3
  s_cselect_b32 s27, 8, -1
  s_add_i32 s15, s15, s27
  s_max_i32 s15, s15, 0
  s_add_u32 s24, s24, s15
  s_branch L_pce59
L_pcwe60:
  s_memrealtime s[22:23]
  s_waitcnt lgkmcnt(0)
  s_sub_u32 s26, s22, s24
  s_cmp_lt_u32 s26, 1694
  s_cbranch_scc1 L_pcwe60
  s_getreg_b32 s27, hwreg(HW_REG_IB_STS, 0, 4)
  s_sub_u32 s24, s24, s15
  s_lshr_b32 s26, s15, 4
  s_sub_u32 s15, s15, s26
  s_cmp_ge_u32 s27, 3
  s_cselect_b32 s27, 8, -1
  s_add_i32 s15, s15, s27
  s_max_i32 s15, s15, 0
  s_add_u32 s24, s24, s15
  s_branch L_pce60
L_pcwe61:
  s_memrealtime s[22:23]
  s_waitcnt lgkmcnt(0)
  s_sub_u32 s26, s22, s24
  s_cmp_lt_u32 s26, 1720
  s_cbranch_scc1 L_pcwe61
  s_getreg_b32 s27, hwreg(HW_REG_IB_STS, 0, 4)
  s_sub_u32 s24, s24, s15
  s_lshr_b32 s26, s15, 4
  s_sub_u32 s15, s15, s26
  s_cmp_ge_u32 s27, 3
  s_cselect_b32 s27, 8, -1
  s_add_i32 s15, s15, s27
  s_max_i32 s15, s15, 0
  s_add_u32 s24, s24, s15
  s_branch L_pce61
L_pcwe62:
  s_memrealtime s[22:23]
  s_waitcnt lgkmcnt(0)
  s_sub_u32 s26, s22, s24
  s_cmp_lt_u32 s26, 1746
  s_cbranch_scc1 L_pcwe62
  s_getreg_b32 s27, hwreg(HW_REG_IB_STS, 0, 4)
  s_sub_u32 s24, s24, s15
  s_lshr_b32 s26, s15, 4
  s_sub_u32 s15, s15, s26
  s_cmp_ge_u32 s27, 3
  s_cselect_b32 s27, 8, -1
  s_add_i32 s15, s15, s27
  s_max_i32 s15, s15, 0
  s_add_u32 s24, s24, s15
  s_branch L_pce62
L_pcwe63:
  s_memrealtime s[22:23]
  s_waitcnt lgkmcnt(0)
  s_sub_u32 s26, s22, s24
  s_cmp_lt_u32 s26, 1772
  s_cbranch_scc1 L_pcwe63
  s_branch L_pce63
L_code_end:
.section .rodata,"a"
.p2align 6
.amdhsa_kernel parallel_sum__mha_block_cached__geglu_ffn__decode_kernel
  .amdhsa_next_free_vgpr 168
  .amdhsa_next_free_sgpr 102
  .amdhsa_accum_offset 168
  .amdhsa_group_segment_fixed_size 0
  .amdhsa_kernarg_size 96
  .amdhsa_user_sgpr_count 2
  .amdhsa_user_sgpr_kernarg_segment_ptr 1
  .amdhsa_system_sgpr_workgroup_id_x 1
  .amdhsa_float_denorm_mode_32 3
.end_amdhsa_kernel
```
